```python
import torch

def _softmax(x, axis=-1):
    return torch.softmax(x, dim=axis)
def _gelu(x):
    return torch.nn.functional.gelu(x, approximate="tanh")
def _silu(x):
    return torch.nn.functional.silu(x)
def _sigmoid(x):
    return torch.sigmoid(x)
def _layernorm(x, axis=-1, eps=1e-5):
    m = x.mean(dim=axis, keepdim=True)
    v = x.var(dim=axis, keepdim=True, unbiased=False)
    return (x - m) / torch.sqrt(v + eps)
def _scatter_add(tgt, idx, src, axis=0):
    return tgt.clone().index_add_(axis, idx, src)
def _segment_sum(src, seg, n):
    out = torch.zeros((n,) + src.shape[1:], dtype=src.dtype)
    return out.index_add_(0, seg, src)
def _pad(x, pw):
    flat = tuple(v for pair in reversed(pw) for v in pair)
    return torch.nn.functional.pad(x, flat)

kernel_name = 'sequential_preLN__sliding_block_cached__geglu_ffn__decode'

def setup_inputs():

    _w = (lambda a: (lambda t: t.to(torch.bfloat16) if t.is_floating_point() else t)(torch.as_tensor(a)))
    def _A_setup():
        B, Sq, D = 4, 1, 576
        Hq, Hkv, Sk, Dh = 32, 16, 8192, 128
        assert Hq % Hkv == 0, (Hq, Hkv)
        return {
            "x": _w((lambda *s: torch.randn(*s, dtype=torch.bfloat16) * 0.05)(B, Sq, D)),
            "k_cache": _w((lambda *s: torch.randn(*s, dtype=torch.bfloat16) * 3.2)(B, Hkv, Sk, Dh)),
            "v_cache": _w((lambda *s: torch.randn(*s, dtype=torch.bfloat16) * 0.4)(B, Hkv, Sk, Dh)),
            "wq": _w((lambda *s: torch.randn(*s, dtype=torch.bfloat16) * 3.2)(D, Hq * Dh) * (D ** -0.5)),
            "wo": _w((lambda *s: torch.randn(*s, dtype=torch.bfloat16) * 0.4)(Hq * Dh, D) * ((Hq * Dh) ** -0.5)),
        }
    _A_in = _A_setup()

    def _B_setup():
        B, S, D, F = 4, 1, 576, 4608
        return {
            "x": _w((lambda *s: torch.randn(*s, dtype=torch.bfloat16) * 0.05)(B, S, D)),
            "w_gate": _w((lambda *s: torch.randn(*s, dtype=torch.bfloat16) * 0.05)(D, F)),
            "w_up": _w((lambda *s: torch.randn(*s, dtype=torch.bfloat16) * 0.05)(D, F)),
            "w_down": _w((lambda *s: torch.randn(*s, dtype=torch.bfloat16) * 0.05)(F, D)),
        }
    _B_in = _B_setup()

    return {
        "A_x": _A_in["x"],
        "A_k_cache": _A_in["k_cache"],
        "A_v_cache": _A_in["v_cache"],
        "A_wq": _A_in["wq"],
        "A_wo": _A_in["wo"],
        "B_x": _B_in["x"],
        "B_w_gate": _B_in["w_gate"],
        "B_w_up": _B_in["w_up"],
        "B_w_down": _B_in["w_down"],
    }

def reference(A_x, A_k_cache, A_v_cache, A_wq, A_wo, B_x, B_w_gate, B_w_up, B_w_down):
    def _A_ref(x, k_cache, v_cache, wq, wo):
        B, Sq, D = x.shape
        Hq, Dh = 32, 128
        Hkv, Sk = k_cache.shape[1], k_cache.shape[2]
        W = min(4096, max(256, Sk // 4))
        rep = Hq // Hkv
        q = (lambda x, *d: x.permute(*d))((x @ wq).reshape(B, Sq, Hq, Dh), 0, 2, 1, 3)
        k = (lambda x, n, axis: torch.repeat_interleave(x, n, dim=axis))(k_cache[:, :, Sk - W:, :], rep, axis=1)
        v = (lambda x, n, axis: torch.repeat_interleave(x, n, dim=axis))(v_cache[:, :, Sk - W:, :], rep, axis=1)
        scores = torch.einsum("bhqd,bhkd->bhqk", q, k) * (Dh ** -0.5)
        p = _softmax(scores, axis=-1)
        o = torch.einsum("bhqk,bhkd->bhqd", p, v)
        return (lambda x, *d: x.permute(*d))(o, 0, 2, 1, 3).reshape(B, Sq, Hq * Dh) @ wo

    def _B_ref(x, w_gate, w_up, w_down):
        return (_gelu(x @ w_gate) * (x @ w_up)) @ w_down

    x = A_x
    h = x + _A_ref(_layernorm(x, axis=-1), A_k_cache, A_v_cache, A_wq, A_wo)
    h2 = h + _B_ref(_layernorm(h, axis=-1), B_w_gate, B_w_up, B_w_down)
    return h2
```

```asm
; @launch grid=(256,1,1) block=(512,1,1) lds=131648
.amdgcn_target "amdgcn-amd-amdhsa--gfx950"
.text
.globl sequential_preLN__sliding_block_cached__geglu_ffn__decode_kernel
.p2align 8
.type sequential_preLN__sliding_block_cached__geglu_ffn__decode_kernel,@function
sequential_preLN__sliding_block_cached__geglu_ffn__decode_kernel:
    s_cmpk_ge_u32 s2, 256
    s_cbranch_scc1 L_end
    s_load_dwordx16 s[4:19], s[0:1], 0
    s_load_dwordx8 s[20:27], s[0:1], 64
    v_readfirstlane_b32 s86, v0
    v_and_b32 v1, 63, v0
    s_and_b32 s57, s2, 7
    s_lshr_b32 s58, s2, 3
    s_lshr_b32 s86, s86, 6
    s_and_b32 s56, s86, 3
    s_lshr_b32 s90, s58, 4
    s_lshl1_add_u32 s59, s57, s90
    s_bfe_u32 s61, s2, 0x20005
    s_and_b32 s62, s58, 3
    s_lshl4_add_u32 s90, s61, s59
    s_lshl4_add_u32 s90, s90, 12
    s_lshl2_add_u32 s90, s90, s62
    s_lshl_b32 s60, s90, 15
    s_lshl3_add_u32 s80, s58, s58
    s_add_u32 s80, s80, s57
    s_add_u32 s80, s80, s56
    s_cmp_lt_u32 s86, 4
    s_cbranch_scc1 L_VP
    v_and_b32 v2, 14, v1
    v_lshlrev_b32 v2, 7, v2
    v_and_b32 v28, 48, v1
    v_lshl_add_u32 v2, v28, 1, v2
    v_and_b32 v29, 1, v1
    v_lshl_add_u32 v2, v29, 4, v2
    s_and_b32 s93, s80, 24
    s_and_b32 s90, s80, 7
    s_lshl2_add_u32 s90, s93, s90
    s_lshl_b32 s90, s90, 12
    s_mov_b32 s30, 425984
    s_mov_b32 s31, 0x20000
    s_getpc_b64 s[40:41]
L_pc:
    s_and_b32 s91, s58, 7
    s_lshl2_add_u32 s91, s91, s56
    v_and_b32 v4, 3, v1
    v_lshl_add_u32 v4, s91, 2, v4
    v_lshlrev_b32 v4, 7, v4
    v_min_u32 v4, L_codeend-L_pc-4, v4
    v_mov_b32 v5, 0
    v_lshl_add_u64 v[4:5], v[4:5], 0, s[40:41]
    global_load_dword v23, v[4:5], off
    s_waitcnt lgkmcnt(0)
    s_add_u32 s28, s6, s60
    s_addc_u32 s29, s7, 0
    buffer_load_dwordx4 v[32:35], v2, s[28:31], s90 offen offset:0 nt
    buffer_load_dwordx4 v[36:39], v2, s[28:31], s90 offen offset:128 nt
    s_branch L_KW
L_VP:
    s_setprio 2
    s_mov_b32 s87, 0xffffff00
    s_mov_b32 s88, 0xffff0000
    s_sub_u32 s84, s58, 18
    s_mul_i32 s82, s57, 36864
    s_sub_u32 s90, s58, 16
    s_cmp_ge_u32 s58, 27
    s_cselect_b32 s83, s90, s58
    s_cmp_lt_u32 s84, 9
    s_cbranch_scc1 L_VP_wo
    s_lshr_b32 s90, s83, 2
    s_mul_i32 s90, s90, 1179648
    s_and_b32 s91, s83, 3
    s_lshl2_add_u32 s91, s57, s91
    s_lshl_b32 s91, s91, 8
    s_add_u32 s93, s90, s91
    s_sub_u32 s90, s58, 11
    s_cmp_lt_u32 s90, 16
    s_cselect_b32 s38, 0, 1171712
    s_cselect_b32 s93, 0, s93
    s_lshr_b32 s43, s56, 1
    s_and_b32 s90, s56, 1
    s_lshl_b32 s91, s43, 16
    s_lshl_b32 s92, s90, 7
    s_add_u32 s91, s91, s92
    s_mul_i32 s92, s90, 18432
    s_lshl_b32 s90, s43, 10
    s_add_u32 s92, s92, s90
    s_movk_i32 s40, 0x2000
    s_mov_b32 s41, 131072
    s_movk_i32 s42, 2048
    s_waitcnt lgkmcnt(0)
    s_branch L_VP_go
L_VP_wo:
    s_mul_i32 s90, s57, 589824
    s_lshl_b32 s91, s84, 7
    s_add_u32 s93, s90, s91
    s_mov_b32 s38, 588800
    s_mov_b32 s43, s56
    s_mul_i32 s91, s56, 9216
    s_lshl_b32 s92, s56, 10
    s_movk_i32 s40, 1152
    s_mov_b32 s41, 36864
    s_movk_i32 s42, 4096
    s_waitcnt lgkmcnt(0)
    s_mov_b64 s[10:11], s[12:13]
L_VP_go:
    s_add_u32 s36, s10, s93
    s_addc_u32 s37, s11, 0
    s_mov_b32 s39, 0x20000
    v_lshrrev_b32 v4, 3, v1
    v_mul_u32_u24 v4, s40, v4
    v_bfe_u32 v28, v1, 4, 1
    s_and_b32 s90, s43, 1
    s_lshl_b32 s90, s90, 1
    v_or_b32 v28, s90, v28
    v_lshlrev_b32 v28, 1, v28
    v_and_b32 v29, 7, v1
    v_xor_b32 v28, v28, v29
    v_lshl_add_u32 v4, v28, 4, v4
    s_mul_i32 s90, s56, 1152
    v_lshlrev_b32 v2, 3, v1
    v_lshlrev_b32 v3, 1, v1
    s_mov_b32 s48, s4
    s_mov_b32 s49, s5
    s_mov_b32 s50, 4608
    s_mov_b32 s51, 0x20000
    s_cmp_eq_u32 s38, 0
    s_cbranch_scc1 L_V2
    s_cmp_lt_u32 s84, 9
    s_cbranch_scc1 L_nox
    buffer_load_dwordx2 v[10:11], v2, s[48:51], s90 offen
    buffer_load_dwordx2 v[12:13], v2, s[48:51], s90 offen offset:512
    buffer_load_ushort v22, v3, s[48:51], s90 offen offset:1024
L_nox:
    s_mov_b32 m0, s92
    s_add_u32 s92, s92, s42
    buffer_load_dwordx4 v4, s[36:39], s91 offen nt lds
    s_add_u32 s91, s91, s41
    s_mov_b32 m0, s92
    s_add_u32 s92, s92, s42
    buffer_load_dwordx4 v4, s[36:39], s91 offen nt lds
    s_add_u32 s91, s91, s41
    s_mov_b32 m0, s92
    s_add_u32 s92, s92, s42
    buffer_load_dwordx4 v4, s[36:39], s91 offen nt lds
    s_add_u32 s91, s91, s41
    s_mov_b32 m0, s92
    s_add_u32 s92, s92, s42
    buffer_load_dwordx4 v4, s[36:39], s91 offen nt lds
    s_add_u32 s91, s91, s41
    s_mov_b32 s44, s91
    s_mov_b32 s45, s92
    s_branch L_V2
L_KW:
    s_mov_b32 s87, 0xffffff00
    s_mov_b32 s88, 0xffff0000
    s_sub_u32 s84, s58, 18
    s_mul_i32 s82, s57, 36864
    s_load_dword s63, s[26:27], 589836
    v_lshrrev_b32 v28, 4, v1
    s_mov_b32 s32, s26
    s_mov_b32 s33, s27
    s_mov_b32 s34, 2097152
    s_mov_b32 s35, 0x20000
    s_waitcnt lgkmcnt(0)
    s_add_u32 s63, s63, 1
    s_and_b32 s63, s63, 0xff
    v_mov_b32 v31, s63
    s_getreg_b32 s11, hwreg(HW_REG_XCC_ID, 0, 4)
    s_mul_i32 s91, s63, 0x01010100
    s_or_b32 s11, s11, s91
    s_lshl_b32 s10, s57, 7
    s_add_u32 s10, s10, 917504
    s_cmp_lg_u32 s56, 0
    s_cbranch_scc1 L_noxt
    s_setprio 3
    s_lshl_b32 s91, s58, 2
    v_mov_b32 v9, s91
    v_mov_b32 v10, s11
    s_mov_b64 exec, 1
    buffer_store_dword v10, v9, s[32:35], s10 offen
    s_mov_b64 exec, -1
    s_setprio 0
L_noxt:
    v_bfe_u32 v3, v1, 1, 1
    v_mul_u32_u24 v3, 384, v3
    v_lshl_add_u32 v3, v28, 5, v3
    v_lshl_add_u32 v3, v29, 4, v3
    v_add_u32 v3, 116672, v3
    v_mul_u32_u24 v4, 576, v29
    v_bfe_u32 v5, v1, 1, 2
    v_mul_u32_u24 v5, 144, v5
    s_mul_i32 s91, s56, 1152
    s_add_u32 s91, s91, 117440
    v_add3_u32 v4, v4, v5, s91
    v_lshrrev_b32 v5, 3, v1
    v_lshl_add_u32 v4, v5, 2, v4
    s_lshl_b32 s91, s56, 4
    s_add_u32 s91, s91, 122048
    v_lshl_add_u32 v5, v29, 3, s91
    v_cmp_eq_u32 s[96:97], 1, v29
    s_mov_b32 s9, 12
    s_mov_b32 s91, 133955584
    s_bitcmp1_b32 s91, s58
    s_cselect_b32 s9, 15, s9
    s_mov_b32 s91, 210944
    s_bitcmp1_b32 s91, s58
    s_cselect_b32 s9, 10, s9
    s_mov_b32 s91, 49152
    s_cmp_eq_u32 s57, 3
    s_cselect_b32 s91, 245760, s91
    s_bitcmp1_b32 s91, s58
    s_cselect_b32 s9, 12, s9
    s_mov_b32 s91, 536871458
    s_bitcmp1_b32 s91, s58
    s_cselect_b32 s9, 14, s9
    s_sub_u32 s91, s58, 11
    s_cmp_lt_u32 s91, 16
    s_cselect_b32 s14, -3, 6
    s_cmp_lt_u32 s84, 9
    s_cselect_b32 s14, 8, s14
    s_cmp_le_i32 s14, -1
    s_cbranch_scc1 L_ke2
    s_waitcnt vmcnt(3)
    s_cmp_le_i32 s14, 2
    s_cbranch_scc1 L_ke2
    s_waitcnt vmcnt(1)
L_ke2:
    buffer_load_dwordx4 v[40:43], v2, s[28:31], s90 offen offset:2048 nt
    s_cmp_le_i32 s14, 0
    s_cbranch_scc1 L_ke3
    s_waitcnt vmcnt(3)
    s_cmp_le_i32 s14, 3
    s_cbranch_scc1 L_ke3
    s_waitcnt vmcnt(1)
L_ke3:
    buffer_load_dwordx4 v[44:47], v2, s[28:31], s90 offen offset:2176 nt
    s_cmp_le_i32 s14, 1
    s_cbranch_scc1 L_ke4
    s_waitcnt vmcnt(3)
    s_cmp_le_i32 s14, 4
    s_cbranch_scc1 L_ke4
    s_waitcnt vmcnt(1)
L_ke4:
    s_add_u32 s90, s80, 4
    s_and_b32 s93, s90, 24
    s_and_b32 s90, s90, 7
    s_lshl2_add_u32 s90, s93, s90
    s_lshl_b32 s90, s90, 12
    buffer_load_dwordx4 v[48:51], v2, s[28:31], s90 offen offset:0 nt
    s_cmp_ge_u32 s9, 15
    s_cbranch_scc1 L_kb5
    s_cmp_ge_u32 s9, 13
    s_cbranch_scc1 L_kb5
    s_cmp_ge_u32 s9, 11
    s_cbranch_scc1 L_kb5
    s_waitcnt vmcnt(4)
L_kb5:
    s_cmp_le_i32 s14, 2
    s_cbranch_scc1 L_ke5
    s_waitcnt vmcnt(3)
    s_cmp_le_i32 s14, 5
    s_cbranch_scc1 L_ke5
    s_waitcnt vmcnt(1)
L_ke5:
    buffer_load_dwordx4 v[52:55], v2, s[28:31], s90 offen offset:128 nt
    s_cmp_ge_u32 s9, 14
    s_cbranch_scc1 L_kb6
    s_waitcnt vmcnt(5)
    s_cmp_ge_u32 s9, 12
    s_cbranch_scc1 L_kb6
    s_waitcnt vmcnt(4)
L_kb6:
    s_cmp_le_i32 s14, 3
    s_cbranch_scc1 L_ke6
    s_waitcnt vmcnt(3)
    s_cmp_le_i32 s14, 6
    s_cbranch_scc1 L_ke6
    s_waitcnt vmcnt(1)
L_ke6:
    buffer_load_dwordx4 v[56:59], v2, s[28:31], s90 offen offset:2048 nt
    s_cmp_ge_u32 s9, 15
    s_cbranch_scc1 L_kb7
    s_waitcnt vmcnt(6)
    s_cmp_ge_u32 s9, 13
    s_cbranch_scc1 L_kb7
    s_waitcnt vmcnt(5)
    s_cmp_ge_u32 s9, 11
    s_cbranch_scc1 L_kb7
    s_waitcnt vmcnt(4)
L_kb7:
    s_cmp_le_i32 s14, 4
    s_cbranch_scc1 L_ke7
    s_waitcnt vmcnt(3)
    s_cmp_le_i32 s14, 7
    s_cbranch_scc1 L_ke7
    s_waitcnt vmcnt(1)
L_ke7:
    buffer_load_dwordx4 v[60:63], v2, s[28:31], s90 offen offset:2176 nt
    s_waitcnt vmcnt(6)
    s_cmp_ge_u32 s9, 14
    s_cbranch_scc1 L_kb8
    s_waitcnt vmcnt(5)
    s_cmp_ge_u32 s9, 12
    s_cbranch_scc1 L_kb8
    s_waitcnt vmcnt(4)
L_kb8:
    s_cmp_le_i32 s14, 5
    s_cbranch_scc1 L_ke8
    s_waitcnt vmcnt(3)
L_ke8:
    s_add_u32 s90, s80, 8
    s_and_b32 s93, s90, 24
    s_and_b32 s90, s90, 7
    s_lshl2_add_u32 s90, s93, s90
    s_lshl_b32 s90, s90, 12
    buffer_load_dwordx4 v[64:67], v2, s[28:31], s90 offen offset:0 nt
    s_waitcnt vmcnt(7)
    s_cmp_ge_u32 s9, 15
    s_cbranch_scc1 L_kb9
    s_waitcnt vmcnt(6)
    s_cmp_ge_u32 s9, 13
    s_cbranch_scc1 L_kb9
    s_waitcnt vmcnt(5)
    s_cmp_ge_u32 s9, 11
    s_cbranch_scc1 L_kb9
    s_waitcnt vmcnt(4)
L_kb9:
    s_cmp_le_i32 s14, 6
    s_cbranch_scc1 L_ke9
    s_waitcnt vmcnt(3)
L_ke9:
    buffer_load_dwordx4 v[68:71], v2, s[28:31], s90 offen offset:128 nt
    s_waitcnt vmcnt(6)
    s_cmp_ge_u32 s9, 14
    s_cbranch_scc1 L_kb10
    s_waitcnt vmcnt(5)
    s_cmp_ge_u32 s9, 12
    s_cbranch_scc1 L_kb10
    s_waitcnt vmcnt(4)
L_kb10:
    s_cmp_le_i32 s14, 7
    s_cbranch_scc1 L_ke10
    s_waitcnt vmcnt(3)
L_ke10:
    buffer_load_dwordx4 v[72:75], v2, s[28:31], s90 offen offset:2048 nt
    s_waitcnt vmcnt(7)
    s_cmp_ge_u32 s9, 15
    s_cbranch_scc1 L_kb11
    s_waitcnt vmcnt(6)
    s_cmp_ge_u32 s9, 13
    s_cbranch_scc1 L_kb11
    s_waitcnt vmcnt(5)
    s_cmp_ge_u32 s9, 11
    s_cbranch_scc1 L_kb11
    s_waitcnt vmcnt(4)
L_kb11:
    buffer_load_dwordx4 v[76:79], v2, s[28:31], s90 offen offset:2176 nt
    s_waitcnt vmcnt(6)
    s_cmp_ge_u32 s9, 14
    s_cbranch_scc1 L_kb12
    s_waitcnt vmcnt(5)
    s_cmp_ge_u32 s9, 12
    s_cbranch_scc1 L_kb12
    s_waitcnt vmcnt(4)
L_kb12:
    s_add_u32 s90, s80, 12
    s_and_b32 s93, s90, 24
    s_and_b32 s90, s90, 7
    s_lshl2_add_u32 s90, s93, s90
    s_lshl_b32 s90, s90, 12
    buffer_load_dwordx4 v[80:83], v2, s[28:31], s90 offen offset:0 nt
    s_barrier
    s_waitcnt vmcnt(7)
    s_cmp_ge_u32 s9, 15
    s_cbranch_scc1 L_kb13
    s_waitcnt vmcnt(6)
    s_cmp_ge_u32 s9, 13
    s_cbranch_scc1 L_kb13
    s_waitcnt vmcnt(5)
    s_cmp_ge_u32 s9, 11
    s_cbranch_scc1 L_kb13
    s_waitcnt vmcnt(4)
L_kb13:
    buffer_load_dwordx4 v[84:87], v2, s[28:31], s90 offen offset:128 nt
    s_waitcnt vmcnt(6)
    s_cmp_ge_u32 s9, 14
    s_cbranch_scc1 L_kb14
    s_waitcnt vmcnt(5)
    s_cmp_ge_u32 s9, 12
    s_cbranch_scc1 L_kb14
    s_waitcnt vmcnt(4)
L_kb14:
    buffer_load_dwordx4 v[88:91], v2, s[28:31], s90 offen offset:2048 nt
    s_waitcnt vmcnt(7)
    s_cmp_ge_u32 s9, 15
    s_cbranch_scc1 L_kb15
    s_waitcnt vmcnt(6)
    s_cmp_ge_u32 s9, 13
    s_cbranch_scc1 L_kb15
    s_waitcnt vmcnt(5)
    s_cmp_ge_u32 s9, 11
    s_cbranch_scc1 L_kb15
    s_waitcnt vmcnt(4)
L_kb15:
    buffer_load_dwordx4 v[92:95], v2, s[28:31], s90 offen offset:2176 nt
    s_waitcnt vmcnt(6)
    s_cmp_ge_u32 s9, 14
    s_cbranch_scc1 L_kb16
    s_waitcnt vmcnt(5)
    s_cmp_ge_u32 s9, 12
    s_cbranch_scc1 L_kb16
    s_waitcnt vmcnt(4)
L_kb16:
    s_add_u32 s90, s80, 16
    s_and_b32 s93, s90, 24
    s_and_b32 s90, s90, 7
    s_lshl2_add_u32 s90, s93, s90
    s_lshl_b32 s90, s90, 12
    buffer_load_dwordx4 v[96:99], v2, s[28:31], s90 offen offset:0 nt
    s_waitcnt vmcnt(7)
    s_cmp_ge_u32 s9, 15
    s_cbranch_scc1 L_kb17
    s_waitcnt vmcnt(6)
    s_cmp_ge_u32 s9, 13
    s_cbranch_scc1 L_kb17
    s_waitcnt vmcnt(5)
    s_cmp_ge_u32 s9, 11
    s_cbranch_scc1 L_kb17
    s_waitcnt vmcnt(4)
L_kb17:
    buffer_load_dwordx4 v[100:103], v2, s[28:31], s90 offen offset:128 nt
    s_waitcnt vmcnt(6)
    s_cmp_ge_u32 s9, 14
    s_cbranch_scc1 L_kb18
    s_waitcnt vmcnt(5)
    s_cmp_ge_u32 s9, 12
    s_cbranch_scc1 L_kb18
    s_waitcnt vmcnt(4)
L_kb18:
    buffer_load_dwordx4 v[104:107], v2, s[28:31], s90 offen offset:2048 nt
    s_waitcnt vmcnt(7)
    s_cmp_ge_u32 s9, 15
    s_cbranch_scc1 L_kb19
    s_waitcnt vmcnt(6)
    s_cmp_ge_u32 s9, 13
    s_cbranch_scc1 L_kb19
    s_waitcnt vmcnt(5)
    s_cmp_ge_u32 s9, 11
    s_cbranch_scc1 L_kb19
    s_waitcnt vmcnt(4)
L_kb19:
    buffer_load_dwordx4 v[108:111], v2, s[28:31], s90 offen offset:2176 nt
    s_waitcnt vmcnt(6)
    s_cmp_ge_u32 s9, 14
    s_cbranch_scc1 L_kb20
    s_waitcnt vmcnt(5)
    s_cmp_ge_u32 s9, 12
    s_cbranch_scc1 L_kb20
    s_waitcnt vmcnt(4)
L_kb20:
    s_add_u32 s90, s80, 20
    s_and_b32 s93, s90, 24
    s_and_b32 s90, s90, 7
    s_lshl2_add_u32 s90, s93, s90
    s_lshl_b32 s90, s90, 12
    buffer_load_dwordx4 v[112:115], v2, s[28:31], s90 offen offset:0 nt
    s_waitcnt vmcnt(7)
    s_cmp_ge_u32 s9, 15
    s_cbranch_scc1 L_kb21
    s_waitcnt vmcnt(6)
    s_cmp_ge_u32 s9, 13
    s_cbranch_scc1 L_kb21
    s_waitcnt vmcnt(5)
    s_cmp_ge_u32 s9, 11
    s_cbranch_scc1 L_kb21
    s_waitcnt vmcnt(4)
L_kb21:
    buffer_load_dwordx4 v[116:119], v2, s[28:31], s90 offen offset:128 nt
    s_waitcnt vmcnt(6)
    s_cmp_ge_u32 s9, 14
    s_cbranch_scc1 L_kb22
    s_waitcnt vmcnt(5)
    s_cmp_ge_u32 s9, 12
    s_cbranch_scc1 L_kb22
    s_waitcnt vmcnt(4)
L_kb22:
    buffer_load_dwordx4 v[120:123], v2, s[28:31], s90 offen offset:2048 nt
    s_waitcnt vmcnt(7)
    s_cmp_ge_u32 s9, 15
    s_cbranch_scc1 L_kb23
    s_waitcnt vmcnt(6)
    s_cmp_ge_u32 s9, 13
    s_cbranch_scc1 L_kb23
    s_waitcnt vmcnt(5)
    s_cmp_ge_u32 s9, 11
    s_cbranch_scc1 L_kb23
    s_waitcnt vmcnt(4)
L_kb23:
    buffer_load_dwordx4 v[124:127], v2, s[28:31], s90 offen offset:2176 nt
    s_waitcnt vmcnt(6)
    s_cmp_ge_u32 s9, 14
    s_cbranch_scc1 L_kb24
    s_waitcnt vmcnt(5)
    s_cmp_ge_u32 s9, 12
    s_cbranch_scc1 L_kb24
    s_waitcnt vmcnt(4)
L_kb24:
    s_add_u32 s90, s80, 24
    s_and_b32 s93, s90, 24
    s_and_b32 s90, s90, 7
    s_lshl2_add_u32 s90, s93, s90
    s_lshl_b32 s90, s90, 12
    buffer_load_dwordx4 v[128:131], v2, s[28:31], s90 offen offset:0 nt
    s_waitcnt vmcnt(7)
    s_cmp_ge_u32 s9, 15
    s_cbranch_scc1 L_kb25
    s_waitcnt vmcnt(6)
    s_cmp_ge_u32 s9, 13
    s_cbranch_scc1 L_kb25
    s_waitcnt vmcnt(5)
    s_cmp_ge_u32 s9, 11
    s_cbranch_scc1 L_kb25
    s_waitcnt vmcnt(4)
L_kb25:
    buffer_load_dwordx4 v[132:135], v2, s[28:31], s90 offen offset:128 nt
    s_waitcnt vmcnt(6)
    s_cmp_ge_u32 s9, 14
    s_cbranch_scc1 L_kb26
    s_waitcnt vmcnt(5)
    s_cmp_ge_u32 s9, 12
    s_cbranch_scc1 L_kb26
    s_waitcnt vmcnt(4)
L_kb26:
    buffer_load_dwordx4 v[136:139], v2, s[28:31], s90 offen offset:2048 nt
    s_waitcnt vmcnt(7)
    s_cmp_ge_u32 s9, 15
    s_cbranch_scc1 L_kb27
    s_waitcnt vmcnt(6)
    s_cmp_ge_u32 s9, 13
    s_cbranch_scc1 L_kb27
    s_waitcnt vmcnt(5)
    s_cmp_ge_u32 s9, 11
    s_cbranch_scc1 L_kb27
    s_waitcnt vmcnt(4)
L_kb27:
    buffer_load_dwordx4 v[140:143], v2, s[28:31], s90 offen offset:2176 nt
    s_waitcnt vmcnt(6)
    s_cmp_ge_u32 s9, 14
    s_cbranch_scc1 L_kb28
    s_waitcnt vmcnt(5)
    s_cmp_ge_u32 s9, 12
    s_cbranch_scc1 L_kb28
    s_waitcnt vmcnt(4)
L_kb28:
    s_add_u32 s90, s80, 28
    s_and_b32 s93, s90, 24
    s_and_b32 s90, s90, 7
    s_lshl2_add_u32 s90, s93, s90
    s_lshl_b32 s90, s90, 12
    buffer_load_dwordx4 v[144:147], v2, s[28:31], s90 offen offset:0 nt
    s_waitcnt vmcnt(7)
    s_cmp_ge_u32 s9, 15
    s_cbranch_scc1 L_kb29
    s_waitcnt vmcnt(6)
    s_cmp_ge_u32 s9, 13
    s_cbranch_scc1 L_kb29
    s_waitcnt vmcnt(5)
    s_cmp_ge_u32 s9, 11
    s_cbranch_scc1 L_kb29
    s_waitcnt vmcnt(4)
L_kb29:
    buffer_load_dwordx4 v[148:151], v2, s[28:31], s90 offen offset:128 nt
    s_waitcnt vmcnt(6)
    s_cmp_ge_u32 s9, 14
    s_cbranch_scc1 L_kb30
    s_waitcnt vmcnt(5)
    s_cmp_ge_u32 s9, 12
    s_cbranch_scc1 L_kb30
    s_waitcnt vmcnt(4)
L_kb30:
    buffer_load_dwordx4 v[152:155], v2, s[28:31], s90 offen offset:2048 nt
    s_waitcnt vmcnt(7)
    s_cmp_ge_u32 s9, 15
    s_cbranch_scc1 L_kb31
    s_waitcnt vmcnt(6)
    s_cmp_ge_u32 s9, 13
    s_cbranch_scc1 L_kb31
    s_waitcnt vmcnt(5)
    s_cmp_ge_u32 s9, 11
    s_cbranch_scc1 L_kb31
    s_waitcnt vmcnt(4)
L_kb31:
    buffer_load_dwordx4 v[156:159], v2, s[28:31], s90 offen offset:2176 nt
    v_and_b32 v8, 31, v1
    v_lshlrev_b32 v8, 2, v8
    buffer_load_dword v8, v8, s[32:35], s10 offen sc1
    s_waitcnt vmcnt(4)
    s_barrier
    s_barrier
    ds_read_b128 v[160:163], v3
    ds_read_b128 v[164:167], v3 offset:128
    s_waitcnt vmcnt(0) lgkmcnt(0)
    v_cmp_ne_u32 vcc, s11, v8
    s_nop 0
    s_cmp_eq_u64 vcc, 0
    s_cselect_b32 s89, 1, 0
    v_mfma_f32_16x16x32_bf16 v[168:171], v[160:163], v[32:35], 0
    v_mfma_f32_16x16x32_bf16 v[168:171], v[164:167], v[36:39], v[168:171]
    v_mfma_f32_16x16x32_bf16 v[172:175], v[160:163], v[40:43], 0
    v_mfma_f32_16x16x32_bf16 v[172:175], v[164:167], v[44:47], v[172:175]
    v_mfma_f32_16x16x32_bf16 v[176:179], v[160:163], v[48:51], 0
    v_mfma_f32_16x16x32_bf16 v[176:179], v[164:167], v[52:55], v[176:179]
    v_mfma_f32_16x16x32_bf16 v[180:183], v[160:163], v[56:59], 0
    v_mfma_f32_16x16x32_bf16 v[180:183], v[164:167], v[60:63], v[180:183]
    v_mfma_f32_16x16x32_bf16 v[208:211], v[160:163], v[64:67], 0
    v_mfma_f32_16x16x32_bf16 v[208:211], v[164:167], v[68:71], v[208:211]
    v_mfma_f32_16x16x32_bf16 v[212:215], v[160:163], v[72:75], 0
    v_mfma_f32_16x16x32_bf16 v[212:215], v[164:167], v[76:79], v[212:215]
    v_mfma_f32_16x16x32_bf16 v[216:219], v[160:163], v[80:83], 0
    v_mfma_f32_16x16x32_bf16 v[216:219], v[164:167], v[84:87], v[216:219]
    v_mfma_f32_16x16x32_bf16 v[220:223], v[160:163], v[88:91], 0
    v_mfma_f32_16x16x32_bf16 v[220:223], v[164:167], v[92:95], v[220:223]
    v_add_f32_dpp v188, v169, v168 quad_perm:[1,1,3,3] row_mask:0x1 bank_mask:0xf
    v_add_f32_dpp v189, v170, v171 quad_perm:[0,0,2,2] row_mask:0x1 bank_mask:0xf
    s_nop 0
    v_add_f32_dpp v188, v173, v172 quad_perm:[1,1,3,3] row_mask:0x2 bank_mask:0xf
    v_add_f32_dpp v189, v174, v175 quad_perm:[0,0,2,2] row_mask:0x2 bank_mask:0xf
    s_nop 0
    v_add_f32_dpp v188, v177, v176 quad_perm:[1,1,3,3] row_mask:0x4 bank_mask:0xf
    v_add_f32_dpp v189, v178, v179 quad_perm:[0,0,2,2] row_mask:0x4 bank_mask:0xf
    s_nop 0
    v_add_f32_dpp v188, v181, v180 quad_perm:[1,1,3,3] row_mask:0x8 bank_mask:0xf
    v_add_f32_dpp v189, v182, v183 quad_perm:[0,0,2,2] row_mask:0x8 bank_mask:0xf
    v_cndmask_b32 v184, v188, v189, s[96:97]
    v_mfma_f32_16x16x32_bf16 v[168:171], v[160:163], v[96:99], 0
    v_mfma_f32_16x16x32_bf16 v[168:171], v[164:167], v[100:103], v[168:171]
    v_mfma_f32_16x16x32_bf16 v[172:175], v[160:163], v[104:107], 0
    v_mfma_f32_16x16x32_bf16 v[172:175], v[164:167], v[108:111], v[172:175]
    v_mfma_f32_16x16x32_bf16 v[176:179], v[160:163], v[112:115], 0
    v_mfma_f32_16x16x32_bf16 v[176:179], v[164:167], v[116:119], v[176:179]
    v_mfma_f32_16x16x32_bf16 v[180:183], v[160:163], v[120:123], 0
    v_mfma_f32_16x16x32_bf16 v[180:183], v[164:167], v[124:127], v[180:183]
    v_add_f32_dpp v188, v209, v208 quad_perm:[1,1,3,3] row_mask:0x1 bank_mask:0xf
    v_add_f32_dpp v189, v210, v211 quad_perm:[0,0,2,2] row_mask:0x1 bank_mask:0xf
    s_nop 0
    v_add_f32_dpp v188, v213, v212 quad_perm:[1,1,3,3] row_mask:0x2 bank_mask:0xf
    v_add_f32_dpp v189, v214, v215 quad_perm:[0,0,2,2] row_mask:0x2 bank_mask:0xf
    s_nop 0
    v_add_f32_dpp v188, v217, v216 quad_perm:[1,1,3,3] row_mask:0x4 bank_mask:0xf
    v_add_f32_dpp v189, v218, v219 quad_perm:[0,0,2,2] row_mask:0x4 bank_mask:0xf
    s_nop 0
    v_add_f32_dpp v188, v221, v220 quad_perm:[1,1,3,3] row_mask:0x8 bank_mask:0xf
    v_add_f32_dpp v189, v222, v223 quad_perm:[0,0,2,2] row_mask:0x8 bank_mask:0xf
    v_cndmask_b32 v185, v188, v189, s[96:97]
    v_mfma_f32_16x16x32_bf16 v[208:211], v[160:163], v[128:131], 0
    v_mfma_f32_16x16x32_bf16 v[208:211], v[164:167], v[132:135], v[208:211]
    v_mfma_f32_16x16x32_bf16 v[212:215], v[160:163], v[136:139], 0
    v_mfma_f32_16x16x32_bf16 v[212:215], v[164:167], v[140:143], v[212:215]
    v_mfma_f32_16x16x32_bf16 v[216:219], v[160:163], v[144:147], 0
    v_mfma_f32_16x16x32_bf16 v[216:219], v[164:167], v[148:151], v[216:219]
    v_mfma_f32_16x16x32_bf16 v[220:223], v[160:163], v[152:155], 0
    v_mfma_f32_16x16x32_bf16 v[220:223], v[164:167], v[156:159], v[220:223]
    v_add_f32_dpp v188, v169, v168 quad_perm:[1,1,3,3] row_mask:0x1 bank_mask:0xf
    v_add_f32_dpp v189, v170, v171 quad_perm:[0,0,2,2] row_mask:0x1 bank_mask:0xf
    s_nop 0
    v_add_f32_dpp v188, v173, v172 quad_perm:[1,1,3,3] row_mask:0x2 bank_mask:0xf
    v_add_f32_dpp v189, v174, v175 quad_perm:[0,0,2,2] row_mask:0x2 bank_mask:0xf
    s_nop 0
    v_add_f32_dpp v188, v177, v176 quad_perm:[1,1,3,3] row_mask:0x4 bank_mask:0xf
    v_add_f32_dpp v189, v178, v179 quad_perm:[0,0,2,2] row_mask:0x4 bank_mask:0xf
    s_nop 0
    v_add_f32_dpp v188, v181, v180 quad_perm:[1,1,3,3] row_mask:0x8 bank_mask:0xf
    v_add_f32_dpp v189, v182, v183 quad_perm:[0,0,2,2] row_mask:0x8 bank_mask:0xf
    v_cndmask_b32 v186, v188, v189, s[96:97]
    v_add_f32_dpp v188, v209, v208 quad_perm:[1,1,3,3] row_mask:0x1 bank_mask:0xf
    v_add_f32_dpp v189, v210, v211 quad_perm:[0,0,2,2] row_mask:0x1 bank_mask:0xf
    s_nop 0
    v_add_f32_dpp v188, v213, v212 quad_perm:[1,1,3,3] row_mask:0x2 bank_mask:0xf
    v_add_f32_dpp v189, v214, v215 quad_perm:[0,0,2,2] row_mask:0x2 bank_mask:0xf
    s_nop 0
    v_add_f32_dpp v188, v217, v216 quad_perm:[1,1,3,3] row_mask:0x4 bank_mask:0xf
    v_add_f32_dpp v189, v218, v219 quad_perm:[0,0,2,2] row_mask:0x4 bank_mask:0xf
    s_nop 0
    v_add_f32_dpp v188, v221, v220 quad_perm:[1,1,3,3] row_mask:0x8 bank_mask:0xf
    v_add_f32_dpp v189, v222, v223 quad_perm:[0,0,2,2] row_mask:0x8 bank_mask:0xf
    v_cndmask_b32 v187, v188, v189, s[96:97]
    v_cvt_pk_bf16_f32 v184, v184, v185
    v_cvt_pk_bf16_f32 v186, v186, v187
    v_and_b32 v185, s88, v184
    v_lshlrev_b32 v184, 16, v184
    v_and_b32 v187, s88, v186
    v_lshlrev_b32 v186, 16, v186
    v_mul_f32 v184, 1035273459, v184
    v_mul_f32 v185, 1035273459, v185
    v_mul_f32 v186, 1035273459, v186
    v_mul_f32 v187, 1035273459, v187
    v_cvt_pk_bf16_f32 v184, v184, v185
    v_cvt_pk_bf16_f32 v186, v186, v187
    v_and_b32 v185, s88, v184
    v_lshlrev_b32 v184, 16, v184
    v_and_b32 v187, s88, v186
    v_lshlrev_b32 v186, 16, v186
    v_max3_f32 v190, v184, v185, v186
    v_max_f32 v190, v190, v187
    s_nop 1
    v_max_f32_dpp v190, v190, v190 quad_perm:[2,3,0,1] row_mask:0xf bank_mask:0xf
    s_nop 1
    v_max_f32_dpp v190, v190, v190 row_ror:4 row_mask:0xf bank_mask:0xf
    s_nop 1
    v_max_f32_dpp v190, v190, v190 row_ror:8 row_mask:0xf bank_mask:0xf
    v_mov_b32 v188, v190
    s_nop 1
    v_permlane16_swap_b32 v188, v190
    v_max_f32 v190, v190, v188
    v_mov_b32 v188, v190
    s_nop 1
    v_permlane32_swap_b32 v188, v190
    v_max_f32 v190, v190, v188
    v_sub_f32 v184, v184, v190
    v_mul_f32 v184, 1069066811, v184
    v_exp_f32 v184, v184
    v_sub_f32 v185, v185, v190
    v_mul_f32 v185, 1069066811, v185
    v_exp_f32 v185, v185
    v_sub_f32 v186, v186, v190
    v_mul_f32 v186, 1069066811, v186
    v_exp_f32 v186, v186
    v_sub_f32 v187, v187, v190
    v_mul_f32 v187, 1069066811, v187
    v_exp_f32 v187, v187
    v_add_f32 v191, v184, v185
    v_add_f32 v188, v186, v187
    v_add_f32 v191, v191, v188
    v_cvt_pk_bf16_f32 v184, v184, v184
    ds_write_b32 v4, v184 offset:0
    v_cvt_pk_bf16_f32 v185, v185, v185
    ds_write_b32 v4, v185 offset:32
    v_cvt_pk_bf16_f32 v186, v186, v186
    ds_write_b32 v4, v186 offset:64
    v_cvt_pk_bf16_f32 v187, v187, v187
    ds_write_b32 v4, v187 offset:96
    v_add_f32_dpp v191, v191, v191 quad_perm:[2,3,0,1] row_mask:0xf bank_mask:0xf
    s_nop 1
    v_add_f32_dpp v191, v191, v191 row_ror:4 row_mask:0xf bank_mask:0xf
    s_nop 1
    v_add_f32_dpp v191, v191, v191 row_ror:8 row_mask:0xf bank_mask:0xf
    v_mov_b32 v188, v191
    s_nop 1
    v_permlane16_swap_b32 v188, v191
    v_add_f32 v191, v191, v188
    v_mov_b32 v188, v191
    s_nop 1
    v_permlane32_swap_b32 v188, v191
    v_add_f32 v191, v191, v188
    s_mov_b64 exec, 3
    ds_write_b64 v5, v[190:191]
    s_mov_b64 exec, -1
    s_waitcnt lgkmcnt(0)
    s_barrier
    s_cmp_lg_u32 s56, 0
    s_cbranch_scc1 L_K_nostat
    ds_read_b64 v[32:33], v5 offset:0
    ds_read_b64 v[34:35], v5 offset:16
    ds_read_b64 v[36:37], v5 offset:32
    ds_read_b64 v[38:39], v5 offset:48
    v_lshlrev_b32 v6, 4, v29
    s_lshl_b32 s91, s57, 5
    s_add_u32 s91, s91, s58
    s_lshl_b32 s91, s91, 5
    s_add_u32 s91, s91, 921600
    s_waitcnt lgkmcnt(0)
    v_max3_f32 v40, v32, v34, v36
    v_max_f32 v40, v40, v38
    v_sub_f32 v32, v32, v40
    v_mul_f32 v32, 1069066811, v32
    v_exp_f32 v32, v32
    v_sub_f32 v34, v34, v40
    v_mul_f32 v34, 1069066811, v34
    v_exp_f32 v34, v34
    v_sub_f32 v36, v36, v40
    v_mul_f32 v36, 1069066811, v36
    v_exp_f32 v36, v36
    v_sub_f32 v38, v38, v40
    v_mul_f32 v38, 1069066811, v38
    v_exp_f32 v38, v38
    s_mul_i32 s92, s63, 0x01010101
    v_mul_f32 v42, v32, v33
    v_fmac_f32 v42, v34, v35
    v_fmac_f32 v42, v36, v37
    v_fmac_f32 v42, v38, v39
    v_mov_b32 v41, s92
    v_mov_b32 v43, s92
    s_mov_b64 exec, 3
    s_cmp_eq_u32 s89, 0
    s_cbranch_scc1 L_sst_s
    buffer_store_dwordx4 v[40:43], v6, s[32:35], s91 offen
L_sst_d:
    s_mov_b64 exec, -1
    s_and_b32 s91, s91, 0xffffff80
    v_and_b32 v6, 3, v1
    v_lshlrev_b32 v6, 5, v6
    v_bfe_u32 v7, v1, 2, 1
    v_lshl_add_u32 v6, v7, 4, v6
    v_lshlrev_b32 v7, 3, v7
    v_add_u32 v7, 130560, v7
    s_mul_i32 s3, s63, 33686018
    s_mov_b32 s81, 0
L_pst:
    buffer_load_dwordx4 v[44:47], v6, s[32:35], s91 offen sc1
    s_add_u32 s81, s81, 1
    s_cmp_gt_u32 s81, 1048576
    s_cbranch_scc1 L_pst_x
L_pst_c:
    s_waitcnt vmcnt(0)
    v_add_u32 v30, v45, v47
    v_cmp_ne_u32 vcc, s3, v30
    s_cbranch_vccnz L_pst
L_pst_x:
    v_max_f32_dpp v48, v44, v44 quad_perm:[1,0,3,2] row_mask:0xf bank_mask:0xf
    s_nop 1
    v_max_f32_dpp v48, v48, v48 quad_perm:[2,3,0,1] row_mask:0xf bank_mask:0xf
    v_sub_f32 v44, v44, v48
    v_mul_f32 v44, 1069066811, v44
    v_exp_f32 v44, v44
    s_nop 0
    v_mul_f32 v49, v44, v46
    s_nop 1
    v_add_f32_dpp v49, v49, v49 quad_perm:[1,0,3,2] row_mask:0xf bank_mask:0xf
    s_nop 1
    v_add_f32_dpp v49, v49, v49 quad_perm:[2,3,0,1] row_mask:0xf bank_mask:0xf
    v_rcp_f32 v49, v49
    s_nop 0
    ds_write_b64 v7, v[48:49]
    s_waitcnt lgkmcnt(0)
L_K_nostat:
    s_cmp_lt_u32 s58, 18
    s_cbranch_scc1 L_K_ffn
    s_cmp_lt_u32 s58, 27
    s_cbranch_scc1 L_K_wo
    s_cmp_lg_u32 s57, 0
    s_cbranch_scc1 L_exit
    s_barrier
    s_barrier
    s_sub_u32 s90, s58, 27
    s_lshl2_add_u32 s90, s90, s56
    s_lshl_b32 s90, s90, 6
    v_add_u32 v2, s90, v1
    v_add_u32 v3, 1280, v2
    v_min_u32 v2, 1727, v2
    v_min_u32 v3, 1727, v3
    v_lshlrev_b32 v2, 7, v2
    v_lshlrev_b32 v3, 7, v3
    s_mov_b32 s90, 589824
    buffer_load_dword v2, v2, s[32:35], s90 offen sc1
    buffer_load_dword v3, v3, s[32:35], s90 offen sc1
    s_branch L_exit
L_K_wo:
    v_mov_b32 v11, 1073741824
    s_lshl3_add_u32 s85, s84, s86
    s_mov_b32 s48, s4
    s_mov_b32 s49, s5
    s_mov_b32 s50, 4608
    s_mov_b32 s51, 0x20000
    v_bfe_u32 v223, v1, 2, 1
    v_mul_u32_u24 v223, 1152, v223
    v_and_b32 v28, 3, v1
    v_lshl_add_u32 v223, v28, 3, v223
    v_lshrrev_b32 v28, 4, v1
    v_lshl_add_u32 v223, v28, 1, v223
    s_and_b32 s90, s85, 1
    s_mul_i32 s90, s90, 2304
    s_lshr_b32 s91, s85, 1
    s_lshl_b32 s91, s91, 5
    s_add_u32 s90, s90, s91
    v_add_u32 v223, s90, v223
    v_mov_b32 v219, 0
    buffer_load_short_d16_hi v219, v223, s[48:51], 0 offen
    v_lshlrev_b32 v216, 4, v1
    v_lshrrev_b32 v29, 5, v1
    s_lshr_b32 s91, s86, 2
    s_mul_i32 s90, s56, 1088
    s_lshl_b32 s91, s91, 9
    s_add_u32 s90, s90, s91
    s_add_u32 s90, s90, 126208
    v_lshl_add_u32 v218, v29, 8, s90
    v_and_b32 v29, 15, v1
    v_lshl_add_u32 v218, v29, 4, v218
    v_bfe_u32 v29, v1, 4, 1
    v_lshl_add_u32 v218, v29, 3, v218
    v_and_b32 v222, 7, v1
    v_lshlrev_b32 v222, 4, v222
    v_lshl_add_u32 v220, v28, 2, v222
    v_lshlrev_b32 v220, 1, v223
    v_and_b32 v29, 8, v1
    v_lshlrev_b32 v29, 27, v29
    v_or_b32 v220, v220, v29
    v_or_b32 v223, v223, v29
    s_mul_i32 s92, s63, 0x101
    v_mov_b32 v221, s92
    s_lshl_b32 s16, s86, 12
    s_add_u32 s16, s16, s82
    s_lshl_b32 s17, s85, 10
    s_add_u32 s17, s17, 491520
    s_mul_i32 s18, s57, 9216
    s_add_u32 s18, s18, 294912
    s_lshl_b32 s90, s57, 3
    s_bfm_b64 s[94:95], 8, s90
    s_lshl_b32 s90, s86, 7
    s_add_u32 s90, s90, 130624
    v_add_u32 v222, s90, v222
    s_mul_i32 s90, s57, 589824
    s_lshl_b32 s91, s84, 7
    s_add_u32 s90, s90, s91
    s_add_u32 s36, s12, s90
    s_addc_u32 s37, s13, 0
    s_mov_b32 s38, 588800
    s_mov_b32 s39, 0x20000
    v_lshrrev_b32 v6, 3, v1
    v_mul_u32_u24 v6, 1152, v6
    v_bfe_u32 v28, v1, 4, 1
    s_and_b32 s90, s56, 1
    s_lshl_b32 s90, s90, 1
    v_or_b32 v28, s90, v28
    v_lshlrev_b32 v28, 1, v28
    v_and_b32 v29, 7, v1
    v_xor_b32 v28, v28, v29
    v_lshl_add_u32 v6, v28, 4, v6
    v_lshrrev_b32 v28, 4, v1
    v_bfe_u32 v29, v1, 2, 2
    v_lshl_add_u32 v7, v28, 3, v29
    v_lshlrev_b32 v7, 7, v7
    v_and_b32 v29, 3, v1
    v_lshl_add_u32 v7, v29, 3, v7
    v_bfe_u32 v8, v1, 3, 2
    v_lshlrev_b32 v8, 5, v8
    s_lshl_b32 s90, s56, 5
    v_xor_b32 v8, s90, v8
    v_add_u32 v7, v7, v8
    ds_read_b64_tr_b16 v[32:33], v7 offset:0
    ds_read_b64_tr_b16 v[34:35], v7 offset:512
    ds_read_b64_tr_b16 v[36:37], v7 offset:4096
    ds_read_b64_tr_b16 v[38:39], v7 offset:4608
    ds_read_b64_tr_b16 v[40:41], v7 offset:8192
    ds_read_b64_tr_b16 v[42:43], v7 offset:8704
    ds_read_b64_tr_b16 v[44:45], v7 offset:12288
    ds_read_b64_tr_b16 v[46:47], v7 offset:12800
    ds_read_b64_tr_b16 v[48:49], v7 offset:16384
    ds_read_b64_tr_b16 v[50:51], v7 offset:16896
    ds_read_b64_tr_b16 v[52:53], v7 offset:20480
    ds_read_b64_tr_b16 v[54:55], v7 offset:20992
    ds_read_b64_tr_b16 v[56:57], v7 offset:24576
    ds_read_b64_tr_b16 v[58:59], v7 offset:25088
    ds_read_b64_tr_b16 v[60:61], v7 offset:28672
    ds_read_b64_tr_b16 v[62:63], v7 offset:29184
    ds_read_b64_tr_b16 v[64:65], v7 offset:32768
    ds_read_b64_tr_b16 v[66:67], v7 offset:33280
    ds_read_b64_tr_b16 v[68:69], v7 offset:36864
    ds_read_b64_tr_b16 v[70:71], v7 offset:37376
    ds_read_b64_tr_b16 v[72:73], v7 offset:40960
    ds_read_b64_tr_b16 v[74:75], v7 offset:41472
    ds_read_b64_tr_b16 v[76:77], v7 offset:45056
    ds_read_b64_tr_b16 v[78:79], v7 offset:45568
    v_and_b32 v9, 3, v1
    v_lshlrev_b32 v13, 6, v9
    v_mul_u32_u24 v9, 1088, v9
    v_lshrrev_b32 v28, 4, v1
    v_lshl_add_u32 v9, v28, 4, v9
    v_add_u32 v9, 126208, v9
    v_bfe_u32 v10, v1, 1, 1
    v_lshlrev_b32 v10, 10, v10
    v_and_b32 v29, 1, v1
    v_lshl_add_u32 v10, v29, 6, v10
    v_lshl_add_u32 v10, v28, 4, v10
    s_lshl2_add_u32 s19, s84, s56
    s_lshl_b32 s19, s19, 11
    s_lshl_b32 s90, s57, 7
    s_add_u32 s19, s19, s90
    s_add_u32 s19, s19, 491520
    v_lshl_add_u32 v13, v28, 4, v13
    s_lshl_b32 s90, s56, 8
    s_add_u32 s90, s90, 130624
    v_add_u32 v13, s90, v13
    s_mov_b32 s13, 2
    s_mov_b32 s44, s20
    s_mov_b32 s45, s21
    s_mov_b32 s46, 5308416
    s_mov_b32 s47, 0x20000
    s_mov_b32 s7, 12
    s_lshl_b32 s4, s7, 5
    s_lshl_b32 s91, s57, 9
    s_add_u32 s4, s4, s91
    s_lshl_b32 s5, s57, 6
    s_add_u32 s5, s5, 3968
    s_cmp_eq_u32 s13, 2
    s_cselect_b32 s5, s5, s4
    s_lshl_b32 s90, s84, 7
    s_mul_i32 s91, s56, 9216
    s_add_u32 s90, s90, s91
    s_mul_i32 s4, s4, 1152
    s_mul_i32 s5, s5, 1152
    s_add_u32 s4, s4, s90
    s_add_u32 s5, s5, s90
    s_lshl_b32 s14, s56, 10
    v_min_u32 v15, 47, v1
    v_lshlrev_b32 v14, 4, v15
    v_bfe_u32 v16, v15, 1, 2
    v_mul_u32_u24 v16, 832, v16
    v_and_b32 v17, 1, v15
    v_lshl_add_u32 v16, v17, 3, v16
    v_lshrrev_b32 v17, 3, v15
    v_lshl_add_u32 v16, v17, 4, v16
    s_mul_i32 s90, s56, 96
    s_add_u32 s90, s90, 126208
    v_add_u32 v16, s90, v16
    s_mul_i32 s6, s57, 9216
    s_lshl_b32 s90, s7, 9
    s_add_u32 s6, s6, s90
    s_mul_i32 s90, s56, 768
    s_add_u32 s6, s6, s90
    s_add_u32 s6, s6, 393216
    s_mul_i32 s91, s56, 9216
    s_lshl_b32 s92, s56, 10
    s_barrier
    s_add_u32 s90, s91, 442368
    s_add_u32 m0, s92, 49152
    s_nop 0
    buffer_load_dwordx4 v6, s[36:39], s90 offen nt lds
    s_add_u32 s90, s91, 479232
    s_add_u32 m0, s92, 53248
    s_nop 0
    buffer_load_dwordx4 v6, s[36:39], s90 offen nt lds
    s_add_u32 s90, s91, 516096
    s_add_u32 m0, s92, 57344
    s_nop 0
    buffer_load_dwordx4 v6, s[36:39], s90 offen nt lds
    s_add_u32 s90, s91, 552960
    s_add_u32 m0, s92, 61440
    s_nop 0
    buffer_load_dwordx4 v6, s[36:39], s90 offen nt lds
    s_waitcnt vmcnt(1)
L_wo_gather:
    s_add_u32 s3, s63, 66
    s_mov_b32 s81, 0
L_pA:
    buffer_load_dwordx4 v[164:167], v216, s[32:35], s16 offen offset:0 sc1
    buffer_load_dwordx4 v[168:171], v216, s[32:35], s16 offen offset:1024 sc1
    buffer_load_dwordx4 v[172:175], v216, s[32:35], s16 offen offset:2048 sc1
    buffer_load_dwordx4 v[176:179], v216, s[32:35], s16 offen offset:3072 sc1
    s_add_u32 s81, s81, 1
    s_cmp_gt_u32 s81, 1048576
    s_cbranch_scc1 L_pA_f0
    s_waitcnt vmcnt(3)
    v_xor_b32 v30, s3, v167
    v_and_b32 v167, s87, v167
    s_waitcnt vmcnt(2)
    v_bitop3_b32 v30, v30, v171, s3 bitop3:0xf6
    v_and_b32 v171, s87, v171
    v_pk_add_f32 v[164:165], v[164:165], v[168:169]
    v_pk_add_f32 v[166:167], v[166:167], v[170:171]
    s_waitcnt vmcnt(1)
    v_bitop3_b32 v30, v30, v175, s3 bitop3:0xf6
    v_and_b32 v175, s87, v175
    v_pk_add_f32 v[164:165], v[164:165], v[172:173]
    v_pk_add_f32 v[166:167], v[166:167], v[174:175]
    s_waitcnt vmcnt(0)
    v_bitop3_b32 v30, v30, v179, s3 bitop3:0xf6
    v_cmp_ne_u32_sdwa vcc, v30, 0 src0_sel:BYTE_0 src1_sel:DWORD
    v_and_b32 v179, s87, v179
    v_pk_add_f32 v[164:165], v[164:165], v[176:177]
    v_pk_add_f32 v[166:167], v[166:167], v[178:179]
    v_cvt_pk_bf16_f32 v224, v164, v165
    v_cvt_pk_bf16_f32 v225, v166, v167
    ds_write_b64 v218, v[224:225]
    s_cbranch_vccnz L_pA
L_pA_f0:
L_pA_x:
    s_cmp_lt_u32 s86, 4
    s_waitcnt lgkmcnt(0)
    s_barrier
    s_cbranch_scc1 L_wo_vset
    ds_read_b128 v[96:99], v9 offset:0
    ds_read_b128 v[100:103], v9 offset:64
    ds_read_b128 v[104:107], v9 offset:128
    ds_read_b128 v[108:111], v9 offset:192
    ds_read_b128 v[112:115], v9 offset:256
    ds_read_b128 v[116:119], v9 offset:320
    ds_read_b128 v[120:123], v9 offset:384
    ds_read_b128 v[124:127], v9 offset:448
    ds_read_b128 v[128:131], v9 offset:512
    ds_read_b128 v[132:135], v9 offset:576
    s_waitcnt lgkmcnt(9)
    v_mfma_f32_16x16x32_bf16 v[160:163], v[32:35], v[96:99], 0
    ds_read_b128 v[136:139], v9 offset:640
    s_waitcnt lgkmcnt(9)
    v_mfma_f32_16x16x32_bf16 v[160:163], v[36:39], v[100:103], v[160:163]
    ds_read_b128 v[140:143], v9 offset:704
    s_waitcnt lgkmcnt(9)
    v_mfma_f32_16x16x32_bf16 v[160:163], v[40:43], v[104:107], v[160:163]
    ds_read_b64_tr_b16 v[80:81], v7 offset:49152
    s_waitcnt lgkmcnt(9)
    v_mfma_f32_16x16x32_bf16 v[160:163], v[44:47], v[108:111], v[160:163]
    ds_read_b64_tr_b16 v[82:83], v7 offset:49664
    s_waitcnt lgkmcnt(9)
    v_mfma_f32_16x16x32_bf16 v[160:163], v[48:51], v[112:115], v[160:163]
    ds_read_b128 v[144:147], v9 offset:768
    s_waitcnt lgkmcnt(9)
    v_mfma_f32_16x16x32_bf16 v[160:163], v[52:55], v[116:119], v[160:163]
    ds_read_b64_tr_b16 v[84:85], v7 offset:53248
    s_waitcnt lgkmcnt(9)
    v_mfma_f32_16x16x32_bf16 v[160:163], v[56:59], v[120:123], v[160:163]
    ds_read_b64_tr_b16 v[86:87], v7 offset:53760
    s_waitcnt lgkmcnt(9)
    v_mfma_f32_16x16x32_bf16 v[160:163], v[60:63], v[124:127], v[160:163]
    ds_read_b128 v[148:151], v9 offset:832
    s_waitcnt lgkmcnt(9)
    v_mfma_f32_16x16x32_bf16 v[160:163], v[64:67], v[128:131], v[160:163]
    ds_read_b64_tr_b16 v[88:89], v7 offset:57344
    s_waitcnt lgkmcnt(9)
    v_mfma_f32_16x16x32_bf16 v[160:163], v[68:71], v[132:135], v[160:163]
    ds_read_b64_tr_b16 v[90:91], v7 offset:57856
    s_waitcnt lgkmcnt(9)
    v_mfma_f32_16x16x32_bf16 v[160:163], v[72:75], v[136:139], v[160:163]
    ds_read_b128 v[152:155], v9 offset:896
    s_waitcnt lgkmcnt(9)
    v_mfma_f32_16x16x32_bf16 v[160:163], v[76:79], v[140:143], v[160:163]
    ds_read_b64_tr_b16 v[92:93], v7 offset:61440
    ds_read_b64_tr_b16 v[94:95], v7 offset:61952
    ds_read_b128 v[156:159], v9 offset:960
    s_waitcnt lgkmcnt(9)
    v_mfma_f32_16x16x32_bf16 v[160:163], v[80:83], v[144:147], v[160:163]
    s_waitcnt lgkmcnt(6)
    v_mfma_f32_16x16x32_bf16 v[160:163], v[84:87], v[148:151], v[160:163]
    s_waitcnt lgkmcnt(3)
    v_mfma_f32_16x16x32_bf16 v[160:163], v[88:91], v[152:155], v[160:163]
    s_waitcnt lgkmcnt(0)
    v_mfma_f32_16x16x32_bf16 v[160:163], v[92:95], v[156:159], v[160:163]
    s_mov_b32 exec_lo, 0x000f000f
    s_mov_b32 exec_hi, 0x000f000f
    s_nop 5
    v_and_or_b32 v163, v163, s87, v31
    buffer_store_dwordx4 v[160:163], v10, s[32:35], s19 offen sc1
    ds_write_b128 v13, v[160:163]
    s_waitcnt lgkmcnt(0)
L_wo_red:
    s_barrier
    s_mov_b64 exec, s[94:95]
    ds_read_b128 v[228:231], v222
    s_not_b64 exec, exec
    s_add_u32 s3, s63, 0
    s_mov_b32 s81, 0
L_p1:
    buffer_load_dwordx4 v[228:231], v216, s[32:35], s17 offen sc1
    s_add_u32 s81, s81, 1
    s_cmp_gt_u32 s81, 1048576
    s_cbranch_scc1 L_p1_f0
    s_waitcnt vmcnt(0)
    v_cmp_ne_u32_sdwa vcc, v231, s3 src0_sel:BYTE_0 src1_sel:BYTE_0
    s_cbranch_vccnz L_p1
L_p1_f0:
    s_mov_b64 exec, -1
    s_waitcnt lgkmcnt(0)
    v_and_b32 v231, s87, v231
    s_cmp_eq_u32 s89, 0
    v_permlane32_swap_b32 v228, v230
    v_permlane32_swap_b32 v229, v231
    v_pk_add_f32 v[228:229], v[228:229], v[230:231]
    s_nop 1
    v_permlane16_swap_b32 v228, v229
    v_add_f32 v228, v228, v229
    s_nop 1
    v_add_f32_dpp v228, v228, v228 row_ror:8 row_mask:0xf bank_mask:0xf
    v_add_f32 v219, v219, v228
    v_cvt_pk_bf16_f32 v219, v219, v219
    v_and_or_b32 v219, v219, s88, v221
    s_cbranch_scc1 L_hst0_s
    buffer_store_dword v219, v220, s[32:35], s18 offen
L_hst0_d:
L_p1_x:
    s_cmp_lt_u32 s86, 4
    s_barrier
    s_cbranch_scc1 L_wo_dnv
    s_add_u32 m0, s14, 73728
    s_add_u32 s90, s4, 0
    buffer_load_dwordx4 v6, s[44:47], s90 offen nt lds
    s_add_u32 m0, s14, 77824
    s_add_u32 s90, s4, 36864
    buffer_load_dwordx4 v6, s[44:47], s90 offen nt lds
    s_add_u32 m0, s14, 81920
    s_add_u32 s90, s4, 73728
    buffer_load_dwordx4 v6, s[44:47], s90 offen nt lds
    s_add_u32 m0, s14, 86016
    s_add_u32 s90, s4, 110592
    buffer_load_dwordx4 v6, s[44:47], s90 offen nt lds
    s_add_u32 m0, s14, 90112
    s_add_u32 s90, s5, 147456
    buffer_load_dwordx4 v6, s[44:47], s90 offen nt lds
    s_add_u32 m0, s14, 94208
    s_add_u32 s90, s5, 184320
    buffer_load_dwordx4 v6, s[44:47], s90 offen nt lds
    s_waitcnt vmcnt(0)
    s_barrier
    s_branch L_act
L_wo_dnv:
    s_barrier
    ds_read_b64_tr_b16 v[32:33], v22 offset:0
    ds_read_b64_tr_b16 v[34:35], v22 offset:512
    ds_read_b64_tr_b16 v[36:37], v22 offset:4096
    ds_read_b64_tr_b16 v[38:39], v22 offset:4608
    ds_read_b64_tr_b16 v[40:41], v22 offset:8192
    ds_read_b64_tr_b16 v[42:43], v22 offset:8704
    ds_read_b64_tr_b16 v[44:45], v22 offset:12288
    ds_read_b64_tr_b16 v[46:47], v22 offset:12800
    ds_read_b64_tr_b16 v[48:49], v22 offset:16384
    ds_read_b64_tr_b16 v[50:51], v22 offset:16896
    ds_read_b64_tr_b16 v[52:53], v22 offset:20480
    ds_read_b64_tr_b16 v[54:55], v22 offset:20992
    s_cmp_eq_u32 s57, 0
    s_cselect_b32 s89, s89, 0
    s_cmp_eq_u32 s89, 0
    s_waitcnt lgkmcnt(0)
    s_barrier
    ds_read_b128 v[160:163], v21 offset:0
    ds_read_b128 v[164:167], v21 offset:64
    ds_read_b128 v[168:171], v21 offset:128
    ds_read_b128 v[172:175], v21 offset:192
    ds_read_b128 v[176:179], v21 offset:256
    ds_read_b128 v[180:183], v21 offset:320
    s_waitcnt lgkmcnt(5)
    v_mfma_f32_16x16x32_bf16 v[140:143], v[32:35], v[160:163], 0
    s_waitcnt lgkmcnt(4)
    v_mfma_f32_16x16x32_bf16 v[140:143], v[36:39], v[164:167], v[140:143]
    s_waitcnt lgkmcnt(3)
    v_mfma_f32_16x16x32_bf16 v[140:143], v[40:43], v[168:171], v[140:143]
    s_waitcnt lgkmcnt(2)
    v_mfma_f32_16x16x32_bf16 v[140:143], v[44:47], v[172:175], v[140:143]
    s_waitcnt lgkmcnt(1)
    v_mfma_f32_16x16x32_bf16 v[140:143], v[48:51], v[176:179], v[140:143]
    s_waitcnt lgkmcnt(0)
    v_mfma_f32_16x16x32_bf16 v[140:143], v[52:55], v[180:183], v[140:143]
    s_nop 7
    v_and_or_b32 v143, v143, s87, v31
    s_cbranch_scc0 L_3st_fw
    buffer_store_dwordx4 v[140:143], v11, s[32:35], s21 offen sc1
L_3st_dw:
    s_branch L_last
L_wo_vset:
    s_mov_b32 s13, 2
    v_and_b32 v5, 3, v1
    v_lshrrev_b32 v28, 4, v1
    v_mul_u32_u24 v21, 832, v5
    v_lshl_add_u32 v21, v28, 4, v21
    v_add_u32 v21, 126208, v21
    s_lshl_b32 s90, s56, 5
    v_xor_b32 v22, s90, v7
    v_add_u32 v22, v22, v6
    v_add_u32 v22, 73728, v22
    v_bfe_u32 v11, v1, 1, 1
    v_mul_u32_u24 v11, 3072, v11
    v_and_b32 v8, 1, v1
    v_lshl_add_u32 v11, v8, 6, v11
    v_lshl_add_u32 v11, v28, 4, v11
    v_and_b32 v8, 12, v1
    v_lshl_add_u32 v11, v8, 26, v11
    s_lshl2_add_u32 s21, s84, s56
    s_mul_i32 s21, s21, 6144
    s_mul_i32 s90, s57, 3
    s_add_u32 s90, s90, s13
    s_lshl_b32 s90, s90, 7
    s_add_u32 s21, s21, s90
    s_add_u32 s21, s21, 589824
    s_branch L_wo_red
L_last:
    s_cmp_lg_u32 s57, 0
    s_cbranch_scc1 L_exit
    s_mul_i32 s17, s85, 3072
    s_add_u32 s17, s17, 589824
    v_and_b32 v224, s88, v219
    s_cmp_lt_u32 s86, 6
    s_cbranch_scc1 L_exit
L_fin:
    s_mov_b32 s52, s22
    s_mov_b32 s53, s23
    s_mov_b32 s54, 4608
    s_mov_b32 s55, 0x20000
    s_add_u32 s3, s63, 0
    s_mov_b32 s81, 0
L_p3:
    buffer_load_dwordx4 v[32:35], v216, s[32:35], s17 offen offset:0 sc1
    buffer_load_dwordx4 v[36:39], v216, s[32:35], s17 offen offset:1024 sc1
    buffer_load_dwordx4 v[40:43], v216, s[32:35], s17 offen offset:2048 sc1
    s_add_u32 s81, s81, 1
    s_cmp_gt_u32 s81, 1048576
    s_cbranch_scc1 L_p3_f0
    s_waitcnt vmcnt(2)
    v_xor_b32 v30, s3, v35
    v_and_b32 v35, s87, v35
    s_waitcnt vmcnt(1)
    v_bitop3_b32 v30, v30, v39, s3 bitop3:0xf6
    v_and_b32 v39, s87, v39
    v_pk_add_f32 v[32:33], v[32:33], v[36:37]
    v_pk_add_f32 v[34:35], v[34:35], v[38:39]
    s_waitcnt vmcnt(0)
    v_bitop3_b32 v30, v30, v43, s3 bitop3:0xf6
    v_cmp_ne_u32_sdwa vcc, v30, 0 src0_sel:BYTE_0 src1_sel:DWORD
    v_and_b32 v43, s87, v43
    v_pk_add_f32 v[32:33], v[32:33], v[40:41]
    v_pk_add_f32 v[34:35], v[34:35], v[42:43]
    s_cbranch_vccnz L_p3
L_p3_f0:
    s_nop 0
    v_permlane32_swap_b32 v32, v34
    v_permlane32_swap_b32 v33, v35
    v_pk_add_f32 v[32:33], v[32:33], v[34:35]
    s_nop 1
    v_permlane16_swap_b32 v32, v33
    v_add_f32 v32, v32, v33
    s_nop 1
    v_add_f32_dpp v32, v32, v32 row_ror:8 row_mask:0xf bank_mask:0xf
    v_add_f32 v224, v224, v32
    v_cvt_pk_bf16_f32 v224, v224, v224
    buffer_store_short v224, v223, s[52:55], 0 offen
L_p3_x:
    s_branch L_exit
L_K_ffn:
    s_lshr_b32 s90, s58, 1
    s_cmp_ge_u32 s90, 3
    s_addc_u32 s91, s90, 0
    s_cmp_eq_u32 s90, 7
    s_cselect_b32 s91, 3, s91
    s_lshl3_add_u32 s91, s57, s91
    s_add_u32 s92, s57, 64
    s_cmp_eq_u32 s90, 8
    s_cselect_b32 s85, s92, s91
    s_and_b32 s90, s58, 1
    s_mul_i32 s90, s90, 2654208
    s_lshl_b32 s91, s85, 7
    s_add_u32 s90, s90, s91
    s_add_u32 s36, s16, s90
    s_addc_u32 s37, s17, 0
    s_mov_b32 s38, 2645120
    s_mov_b32 s39, 0x20000
    s_add_u32 s40, s18, s90
    s_addc_u32 s41, s19, 0
    s_mov_b32 s42, 2645120
    s_mov_b32 s43, 0x20000
    s_and_b32 s13, s58, 1
    s_lshr_b32 s12, s58, 1
    v_mov_b32 v216, 0
    v_mov_b32 v223, 0
    s_mov_b32 s44, s20
    s_mov_b32 s45, s21
    s_mov_b32 s46, 5308416
    s_mov_b32 s47, 0x20000
    s_mul_i32 s7, s13, 6
    s_lshl_b32 s4, s7, 5
    s_lshl_b32 s91, s57, 9
    s_add_u32 s4, s4, s91
    s_lshl_b32 s5, s57, 6
    s_add_u32 s5, s5, 3968
    s_cmp_eq_u32 s13, 2
    s_cselect_b32 s5, s5, s4
    s_lshl_b32 s90, s12, 7
    s_mul_i32 s91, s56, 9216
    s_add_u32 s90, s90, s91
    s_mul_i32 s4, s4, 1152
    s_mul_i32 s5, s5, 1152
    s_add_u32 s4, s4, s90
    s_add_u32 s5, s5, s90
    s_lshl_b32 s14, s56, 10
    v_min_u32 v15, 47, v1
    v_lshlrev_b32 v14, 4, v15
    v_bfe_u32 v16, v15, 1, 2
    v_mul_u32_u24 v16, 832, v16
    v_and_b32 v17, 1, v15
    v_lshl_add_u32 v16, v17, 3, v16
    v_lshrrev_b32 v17, 3, v15
    v_lshl_add_u32 v16, v17, 4, v16
    s_mul_i32 s90, s56, 96
    s_add_u32 s90, s90, 126208
    v_add_u32 v16, s90, v16
    s_mul_i32 s6, s57, 9216
    s_lshl_b32 s90, s7, 9
    s_add_u32 s6, s6, s90
    s_mul_i32 s90, s56, 768
    s_add_u32 s6, s6, s90
    s_add_u32 s6, s6, 393216
    v_lshrrev_b32 v6, 3, v1
    v_mul_u32_u24 v6, 1152, v6
    v_bfe_u32 v28, v1, 4, 1
    s_and_b32 s90, s56, 1
    s_lshl_b32 s90, s90, 1
    v_or_b32 v28, s90, v28
    v_lshlrev_b32 v28, 1, v28
    v_and_b32 v29, 7, v1
    v_xor_b32 v28, v28, v29
    v_lshl_add_u32 v6, v28, 4, v6
    v_lshrrev_b32 v7, 3, v1
    v_mul_u32_u24 v7, 9216, v7
    v_bfe_u32 v28, v1, 4, 1
    s_and_b32 s90, s56, 1
    s_lshl_b32 s90, s90, 1
    v_or_b32 v28, s90, v28
    v_lshlrev_b32 v28, 1, v28
    v_and_b32 v29, 7, v1
    v_xor_b32 v28, v28, v29
    v_lshl_add_u32 v7, v28, 4, v7
    v_xor_b32 v12, 16, v7
    v_and_b32 v29, 3, v1
    s_mul_i32 s91, s56, 73728
    s_mul_i32 s90, s56, 1216
    s_add_u32 s90, s90, 110592
    v_lshl_add_u32 v10, v1, 3, s90
    v_lshl_add_u32 v11, v1, 1, s90
    s_lshl_b32 s90, s56, 3
    s_add_u32 s90, s90, 130576
    v_mov_b32 v13, s90
    s_mov_b32 s11, 0x07060302
    v_lshlrev_b32 v8, 4, v1
    v_lshlrev_b32 v9, 2, v1
    s_lshl2_add_u32 s16, s57, s56
    s_mul_i32 s16, s16, 2304
    s_add_u32 s16, s16, 294912
    s_add_u32 s17, s16, 1024
    s_add_u32 s18, s16, 2048
    s_lshr_b32 s90, s58, 1
    s_and_b32 s92, s58, 1
    s_mul_i32 s92, s92, 3
    s_lshl3_add_u32 s90, s90, s92
    s_add_u32 s85, s90, s56
    v_and_b32 v28, 3, v1
    v_lshlrev_b32 v223, 3, v28
    v_lshrrev_b32 v28, 4, v1
    v_lshl_add_u32 v223, v28, 1, v223
    s_lshr_b32 s90, s85, 1
    s_lshl_b32 s90, s90, 5
    v_add_u32 v223, s90, v223
    v_bfe_u32 v28, v1, 2, 1
    s_and_b32 s90, s85, 1
    v_lshl_add_u32 v28, s90, 1, v28
    v_mul_u32_u24 v222, 1216, v28
    v_mul_u32_u24 v28, 1152, v28
    v_add_u32 v222, v222, v223
    v_add_u32 v222, 110592, v222
    v_add_u32 v223, v223, v28
    v_and_b32 v28, 8, v1
    v_lshl_add_u32 v223, v28, 27, v223
    v_lshlrev_b32 v216, 4, v1
    v_mov_b32 v224, 0
    s_lshr_b32 s90, s58, 1
    s_cmp_lg_u32 s90, 6
    s_cbranch_scc1 L_noat
    s_and_b32 s90, s58, 1
    s_lshl2_add_u32 s90, s90, s56
    s_lshl3_add_u32 s90, s57, s90
    s_mul_i32 s90, s90, 1152
    s_add_u32 s90, s90, 393216
    v_min_u32 v52, 8, v1
    v_lshlrev_b32 v52, 7, v52
    buffer_load_dword v52, v52, s[32:35], s90 offen sc1
L_noat:
    s_cmp_lg_u32 s58, 11
    s_cbranch_scc1 L_noht
    buffer_load_dwordx4 v[64:67], v8, s[32:35], s16 offen sc1
    buffer_load_dwordx4 v[68:71], v8, s[32:35], s17 offen sc1
    buffer_load_dword v72, v9, s[32:35], s18 offen sc1
    s_add_u32 s90, s82, s14
    s_add_u32 s90, s90, 32768
    buffer_load_dwordx4 v[52:55], v8, s[32:35], s90 offen sc1
L_noht:
    s_mul_i32 s3, s63, 2313
    s_mov_b32 s81, 0
    s_barrier
    s_add_u32 m0, s14, 0
    s_add_u32 s90, s91, 0
    buffer_load_dwordx4 v7, s[36:39], s90 offen nt lds
    s_add_u32 m0, s14, 36864
    s_add_u32 s90, s91, 0
    buffer_load_dwordx4 v12, s[40:43], s90 offen nt lds
    s_add_u32 m0, s14, 4096
    s_add_u32 s90, s91, 294912
    buffer_load_dwordx4 v7, s[36:39], s90 offen nt lds
    s_barrier
    s_add_u32 m0, s14, 40960
    s_add_u32 s90, s91, 294912
    buffer_load_dwordx4 v12, s[40:43], s90 offen nt lds
    s_add_u32 m0, s14, 8192
    s_add_u32 s90, s91, 589824
    buffer_load_dwordx4 v7, s[36:39], s90 offen nt lds
    s_add_u32 m0, s14, 45056
    s_add_u32 s90, s91, 589824
    buffer_load_dwordx4 v12, s[40:43], s90 offen nt lds
    s_add_u32 m0, s14, 12288
    s_add_u32 s90, s91, 884736
    buffer_load_dwordx4 v7, s[36:39], s90 offen nt lds
    s_add_u32 m0, s14, 49152
    s_add_u32 s90, s91, 884736
    buffer_load_dwordx4 v12, s[40:43], s90 offen nt lds
    s_add_u32 m0, s14, 16384
    s_add_u32 s90, s91, 1179648
    buffer_load_dwordx4 v7, s[36:39], s90 offen nt lds
    s_add_u32 m0, s14, 53248
    s_add_u32 s90, s91, 1179648
    buffer_load_dwordx4 v12, s[40:43], s90 offen nt lds
    s_add_u32 m0, s14, 20480
    s_add_u32 s90, s91, 1474560
    buffer_load_dwordx4 v7, s[36:39], s90 offen nt lds
    s_add_u32 m0, s14, 57344
    s_add_u32 s90, s91, 1474560
    buffer_load_dwordx4 v12, s[40:43], s90 offen nt lds
    s_waitcnt vmcnt(11)
    s_add_u32 m0, s14, 24576
    s_add_u32 s90, s91, 1769472
    buffer_load_dwordx4 v7, s[36:39], s90 offen nt lds
    s_waitcnt vmcnt(11)
    s_add_u32 m0, s14, 61440
    s_add_u32 s90, s91, 1769472
    buffer_load_dwordx4 v12, s[40:43], s90 offen nt lds
    s_waitcnt vmcnt(11)
    s_add_u32 m0, s14, 28672
    s_add_u32 s90, s91, 2064384
    buffer_load_dwordx4 v7, s[36:39], s90 offen nt lds
    s_waitcnt vmcnt(11)
    s_add_u32 m0, s14, 65536
    s_add_u32 s90, s91, 2064384
    buffer_load_dwordx4 v12, s[40:43], s90 offen nt lds
    s_waitcnt vmcnt(11)
    s_add_u32 m0, s14, 32768
    s_add_u32 s90, s91, 2359296
    buffer_load_dwordx4 v7, s[36:39], s90 offen nt lds
    s_waitcnt vmcnt(11)
    s_add_u32 m0, s14, 69632
    s_add_u32 s90, s91, 2359296
    buffer_load_dwordx4 v12, s[40:43], s90 offen nt lds
    s_waitcnt vmcnt(11)
    s_add_u32 m0, s14, 73728
    s_add_u32 s90, s4, 0
    buffer_load_dwordx4 v6, s[44:47], s90 offen nt lds
    s_waitcnt vmcnt(11)
    s_add_u32 m0, s14, 77824
    s_add_u32 s90, s4, 36864
    buffer_load_dwordx4 v6, s[44:47], s90 offen nt lds
    s_waitcnt vmcnt(11)
    s_add_u32 m0, s14, 81920
    s_add_u32 s90, s4, 73728
    buffer_load_dwordx4 v6, s[44:47], s90 offen nt lds
    s_waitcnt vmcnt(11)
    s_add_u32 m0, s14, 86016
    s_add_u32 s90, s4, 110592
    buffer_load_dwordx4 v6, s[44:47], s90 offen nt lds
    s_waitcnt vmcnt(11)
    s_add_u32 m0, s14, 90112
    s_add_u32 s90, s5, 147456
    buffer_load_dwordx4 v6, s[44:47], s90 offen nt lds
    s_waitcnt vmcnt(11)
    s_add_u32 m0, s14, 94208
    s_add_u32 s90, s5, 184320
    buffer_load_dwordx4 v6, s[44:47], s90 offen nt lds
    s_setprio 1
    s_waitcnt vmcnt(6)
    s_barrier
    s_waitcnt vmcnt(3)
    buffer_load_dwordx4 v[64:67], v8, s[32:35], s16 offen sc1
    buffer_load_dwordx4 v[68:71], v8, s[32:35], s17 offen sc1
    buffer_load_dword v72, v9, s[32:35], s18 offen sc1
    s_waitcnt vmcnt(0)
    v_add3_u32 v30, v64, v65, v66
    v_add3_u32 v30, v30, v67, v68
    v_add3_u32 v30, v30, v69, v70
    v_add3_u32 v30, v30, v71, v72
    v_cmp_ne_u32_sdwa vcc, v30, s3 src0_sel:WORD_0 src1_sel:WORD_0
    v_perm_b32 v48, v65, v64, s11
    v_perm_b32 v49, v67, v66, s11
    v_perm_b32 v50, v69, v68, s11
    v_perm_b32 v51, v71, v70, s11
    ds_write_b64 v10, v[48:49]
    ds_write_b64 v10, v[50:51] offset:512
    ds_write_b16_d16_hi v11, v72 offset:1024
    s_cbranch_vccz L_p2_f0
L_p2:
    buffer_load_dwordx4 v[64:67], v8, s[32:35], s16 offen sc1
    buffer_load_dwordx4 v[68:71], v8, s[32:35], s17 offen sc1
    buffer_load_dword v72, v9, s[32:35], s18 offen sc1
    s_add_u32 s81, s81, 1
    s_cmp_gt_u32 s81, 1048576
    s_cbranch_scc1 L_p2_f0
    s_waitcnt vmcnt(2)
    v_add3_u32 v30, v64, v65, v66
    s_waitcnt vmcnt(1)
    v_add3_u32 v30, v30, v67, v68
    v_add3_u32 v30, v30, v69, v70
    s_waitcnt vmcnt(0)
    v_add3_u32 v30, v30, v71, v72
    v_cmp_ne_u32_sdwa vcc, v30, s3 src0_sel:WORD_0 src1_sel:WORD_0
    v_perm_b32 v48, v65, v64, s11
    v_perm_b32 v49, v67, v66, s11
    v_perm_b32 v50, v69, v68, s11
    v_perm_b32 v51, v71, v70, s11
    ds_write_b64 v10, v[48:49]
    ds_write_b64 v10, v[50:51] offset:512
    ds_write_b16_d16_hi v11, v72 offset:1024
    s_cbranch_vccnz L_p2
L_p2_f0:
    v_and_b32 v32, s88, v64
    v_and_b32 v33, s88, v65
    v_readfirstlane_b32 s12, v32
    v_and_b32 v34, s88, v66
    v_and_b32 v35, s88, v67
    v_and_b32 v36, s88, v68
    v_and_b32 v37, s88, v69
    v_and_b32 v38, s88, v70
    v_and_b32 v39, s88, v71
    v_and_b32 v40, s88, v72
L_p2_x:
    s_waitcnt lgkmcnt(0)
    s_barrier
    s_mov_b32 s13, s12
    s_setprio 3
    v_pk_add_f32 v[32:33], v[32:33], s[12:13] neg_lo:[0,1] neg_hi:[0,1]
    v_pk_add_f32 v[34:35], v[34:35], s[12:13] neg_lo:[0,1] neg_hi:[0,1]
    v_pk_add_f32 v[36:37], v[36:37], s[12:13] neg_lo:[0,1] neg_hi:[0,1]
    v_pk_add_f32 v[38:39], v[38:39], s[12:13] neg_lo:[0,1] neg_hi:[0,1]
    v_subrev_f32 v40, s12, v40
    v_pk_add_f32 v[44:45], v[32:33], v[34:35]
    v_pk_mul_f32 v[46:47], v[32:33], v[32:33]
    v_pk_add_f32 v[44:45], v[44:45], v[36:37]
    v_pk_fma_f32 v[46:47], v[34:35], v[34:35], v[46:47]
    v_pk_add_f32 v[44:45], v[44:45], v[38:39]
    v_pk_fma_f32 v[46:47], v[36:37], v[36:37], v[46:47]
    v_add_f32 v44, v44, v40
    v_pk_fma_f32 v[46:47], v[38:39], v[38:39], v[46:47]
    v_add_f32 v44, v44, v45
    v_fma_f32 v45, v40, v40, v46
    v_add_f32 v45, v45, v47
    s_nop 1
    v_permlane32_swap_b32 v44, v45
    v_add_f32 v44, v44, v45
    s_nop 1
    v_add_f32_dpp v44, v44, v44 quad_perm:[1,0,3,2] row_mask:0xf bank_mask:0xf
    s_nop 1
    v_add_f32_dpp v44, v44, v44 quad_perm:[2,3,0,1] row_mask:0xf bank_mask:0xf
    s_nop 1
    v_add_f32_dpp v44, v44, v44 row_ror:4 row_mask:0xf bank_mask:0xf
    s_nop 1
    v_add_f32_dpp v44, v44, v44 row_ror:8 row_mask:0xf bank_mask:0xf
    s_nop 1
    v_add_f32_dpp v44, v44, v44 row_bcast:15 row_mask:0xa bank_mask:0xf
    v_mul_f32 v44, 0x3AE38E39, v44
    s_nop 0
    v_readlane_b32 s13, v44, 63
    s_nop 1
    v_fma_f32 v45, -v44, v44, s13
    v_add_f32 v44, s12, v44
    v_max_f32 v45, 0, v45
    v_cvt_pk_bf16_f32 v45, v44, v45
    v_lshlrev_b32 v44, 16, v45
    v_and_b32 v45, s88, v45
    v_add_f32 v45, 0x3727C5AC, v45
    v_xor_b32 v44, 0x80000000, v44
    v_cvt_pk_bf16_f32 v45, v45, v45
    v_and_b32 v45, s88, v45
    v_sqrt_f32 v45, v45
    s_nop 0
    v_cvt_pk_bf16_f32 v45, v45, v45
    v_and_b32 v45, s88, v45
    v_rcp_f32 v45, v45
    s_mov_b64 exec, 0x10000
    ds_write_b64 v13, v[44:45]
    s_mov_b64 exec, -1
    s_waitcnt lgkmcnt(0)
    s_barrier
    s_setprio 1
    ds_read_u16_d16_hi v224, v222
    s_mul_i32 s17, s85, 3072
    s_add_u32 s17, s17, 589824
L_act:
    s_mul_i32 s3, s63, 33686018
    s_mov_b32 s81, 0
L_pa:
    buffer_load_dwordx4 v[100:103], v14, s[32:35], s6 offen sc1
    s_add_u32 s81, s81, 1
    s_cmp_gt_u32 s81, 1048576
    s_cbranch_scc1 L_pa_f0
    s_waitcnt vmcnt(0)
    v_add_u32 v30, v101, v103
    v_cmp_ne_u32 vcc, s3, v30
    ds_write2_b32 v16, v100, v102 offset1:1
    s_cbranch_vccnz L_pa
L_pa_f0:
L_pa_x:
L_act_x:
    s_waitcnt lgkmcnt(0)
    s_barrier
    s_cmp_lt_u32 s84, 9
    s_cbranch_scc1 L_last
    s_cmp_lg_u32 s57, 0
    s_cbranch_scc1 L_exit
    s_cmp_lt_u32 s56, 3
    s_cbranch_scc1 L_fin
    s_branch L_exit
L_V2:
    s_load_dword s63, s[26:27], 589836
    s_add_u32 s28, s8, s60
    s_addc_u32 s29, s9, 0
    s_mov_b32 s30, 425984
    s_mov_b32 s31, 0x20000
    s_mov_b32 s32, s26
    s_mov_b32 s33, s27
    s_mov_b32 s34, 2097152
    s_mov_b32 s35, 0x20000
    v_lshrrev_b32 v28, 4, v1
    v_bfe_u32 v29, v1, 2, 2
    v_lshl_add_u32 v6, v28, 3, v29
    v_lshlrev_b32 v6, 7, v6
    v_and_b32 v29, 3, v1
    v_lshl_add_u32 v6, v29, 3, v6
    v_bfe_u32 v7, v1, 3, 2
    v_lshlrev_b32 v7, 5, v7
    s_cmp_eq_u32 s38, 0
    s_cbranch_scc1 L_noln
    s_waitcnt vmcnt(3)
    s_mov_b32 m0, s45
    s_add_u32 s45, s45, s42
    buffer_load_dwordx4 v4, s[36:39], s44 offen nt lds
    s_add_u32 s44, s44, s41
    s_waitcnt vmcnt(3)
    s_mov_b32 m0, s45
    s_add_u32 s45, s45, s42
    buffer_load_dwordx4 v4, s[36:39], s44 offen nt lds
    s_add_u32 s44, s44, s41
    s_waitcnt vmcnt(3)
    s_mov_b32 m0, s45
    s_add_u32 s45, s45, s42
    buffer_load_dwordx4 v4, s[36:39], s44 offen nt lds
    s_add_u32 s44, s44, s41
    s_waitcnt vmcnt(3)
    s_mov_b32 m0, s45
    s_add_u32 s45, s45, s42
    buffer_load_dwordx4 v4, s[36:39], s44 offen nt lds
    s_add_u32 s44, s44, s41
    s_sub_u32 s90, s58, 11
    s_cmp_lt_u32 s90, 16
    s_cbranch_scc1 L_noln
    s_mul_i32 s90, s56, 1216
    s_add_u32 s90, s90, 110592
    v_add_u32 v2, s90, v2
    v_add_u32 v3, s90, v3
    s_waitcnt vmcnt(8)
    v_and_b32 v15, s88, v10
    v_lshlrev_b32 v14, 16, v10
    v_and_b32 v17, s88, v11
    v_lshlrev_b32 v16, 16, v11
    v_and_b32 v19, s88, v12
    v_lshlrev_b32 v18, 16, v12
    v_and_b32 v21, s88, v13
    v_lshlrev_b32 v20, 16, v13
    v_lshlrev_b32 v22, 16, v22
    v_add_f32 v24, v14, v15
    v_add_f32 v25, v16, v17
    v_add_f32 v26, v18, v19
    v_add_f32 v27, v20, v21
    v_add_f32 v24, v24, v25
    v_add_f32 v26, v26, v27
    v_add_f32 v24, v24, v22
    v_add_f32 v24, v24, v26
    s_nop 1
    v_add_f32_dpp v24, v24, v24 quad_perm:[1,0,3,2] row_mask:0xf bank_mask:0xf
    s_nop 1
    v_add_f32_dpp v24, v24, v24 quad_perm:[2,3,0,1] row_mask:0xf bank_mask:0xf
    s_nop 1
    v_add_f32_dpp v24, v24, v24 row_ror:4 row_mask:0xf bank_mask:0xf
    s_nop 1
    v_add_f32_dpp v24, v24, v24 row_ror:8 row_mask:0xf bank_mask:0xf
    v_mov_b32 v25, v24
    s_nop 1
    v_permlane16_swap_b32 v25, v24
    v_add_f32 v24, v24, v25
    v_mov_b32 v25, v24
    s_nop 1
    v_permlane32_swap_b32 v25, v24
    v_add_f32 v24, v24, v25
    v_mul_f32 v24, 0x3AE38E39, v24
    v_sub_f32 v26, v14, v24
    v_mul_f32 v25, v26, v26
    v_sub_f32 v27, v15, v24
    v_fmac_f32 v25, v27, v27
    v_sub_f32 v26, v16, v24
    v_fmac_f32 v25, v26, v26
    v_sub_f32 v27, v17, v24
    v_fmac_f32 v25, v27, v27
    v_sub_f32 v26, v18, v24
    v_fmac_f32 v25, v26, v26
    v_sub_f32 v27, v19, v24
    v_fmac_f32 v25, v27, v27
    v_sub_f32 v26, v20, v24
    v_fmac_f32 v25, v26, v26
    v_sub_f32 v27, v21, v24
    v_fmac_f32 v25, v27, v27
    v_sub_f32 v26, v22, v24
    v_fmac_f32 v25, v26, v26
    v_cvt_pk_bf16_f32 v24, v24, v24
    v_and_b32 v24, s88, v24
    v_add_f32_dpp v25, v25, v25 quad_perm:[1,0,3,2] row_mask:0xf bank_mask:0xf
    s_nop 1
    v_add_f32_dpp v25, v25, v25 quad_perm:[2,3,0,1] row_mask:0xf bank_mask:0xf
    s_nop 1
    v_add_f32_dpp v25, v25, v25 row_ror:4 row_mask:0xf bank_mask:0xf
    s_nop 1
    v_add_f32_dpp v25, v25, v25 row_ror:8 row_mask:0xf bank_mask:0xf
    v_mov_b32 v26, v25
    s_nop 1
    v_permlane16_swap_b32 v26, v25
    v_add_f32 v25, v25, v26
    v_mov_b32 v26, v25
    s_nop 1
    v_permlane32_swap_b32 v26, v25
    v_add_f32 v25, v25, v26
    v_mul_f32 v25, 0x3AE38E39, v25
    v_cvt_pk_bf16_f32 v25, v25, v25
    v_and_b32 v25, s88, v25
    v_add_f32 v25, 0x3727C5AC, v25
    v_cvt_pk_bf16_f32 v25, v25, v25
    v_and_b32 v25, s88, v25
    v_sqrt_f32 v25, v25
    s_nop 0
    v_cvt_pk_bf16_f32 v25, v25, v25
    v_and_b32 v25, s88, v25
    v_rcp_f32 v25, v25
    v_sub_f32 v14, v14, v24
    v_sub_f32 v15, v15, v24
    v_sub_f32 v16, v16, v24
    v_sub_f32 v17, v17, v24
    v_sub_f32 v18, v18, v24
    v_sub_f32 v19, v19, v24
    v_sub_f32 v20, v20, v24
    v_sub_f32 v21, v21, v24
    v_sub_f32 v22, v22, v24
    v_cvt_pk_bf16_f32 v14, v14, v15
    v_cvt_pk_bf16_f32 v16, v16, v17
    v_cvt_pk_bf16_f32 v18, v18, v19
    v_cvt_pk_bf16_f32 v20, v20, v21
    v_cvt_pk_bf16_f32 v22, v22, v22
    v_and_b32 v15, s88, v14
    v_lshlrev_b32 v14, 16, v14
    v_and_b32 v17, s88, v16
    v_lshlrev_b32 v16, 16, v16
    v_and_b32 v19, s88, v18
    v_lshlrev_b32 v18, 16, v18
    v_and_b32 v21, s88, v20
    v_lshlrev_b32 v20, 16, v20
    v_and_b32 v22, s88, v22
    v_mul_f32 v14, v14, v25
    v_mul_f32 v15, v15, v25
    v_mul_f32 v16, v16, v25
    v_mul_f32 v17, v17, v25
    v_mul_f32 v18, v18, v25
    v_mul_f32 v19, v19, v25
    v_mul_f32 v20, v20, v25
    v_mul_f32 v21, v21, v25
    v_mul_f32 v22, v22, v25
    v_cvt_pk_bf16_f32 v14, v14, v15
    v_cvt_pk_bf16_f32 v15, v16, v17
    v_cvt_pk_bf16_f32 v16, v18, v19
    v_cvt_pk_bf16_f32 v17, v20, v21
    v_cvt_pk_bf16_f32 v18, v22, v22
    ds_write_b64 v2, v[14:15]
    ds_write_b64 v2, v[16:17] offset:512
    ds_write_b16 v3, v18 offset:1024
L_noln:
    s_cmp_eq_u32 s38, 0
    s_cbranch_scc1 L_VP_done
    s_waitcnt vmcnt(3)
    s_mov_b32 m0, s45
    s_add_u32 s45, s45, s42
    buffer_load_dwordx4 v4, s[36:39], s44 offen nt lds
    s_add_u32 s44, s44, s41
    s_cmp_ge_u32 s84, 9
    s_cbranch_scc1 L_VP_done
    s_waitcnt vmcnt(3)
    s_mov_b32 m0, s45
    s_add_u32 s45, s45, s42
    buffer_load_dwordx4 v4, s[36:39], s44 offen nt lds
    s_add_u32 s44, s44, s41
    s_waitcnt vmcnt(3)
    s_mov_b32 m0, s45
    s_add_u32 s45, s45, s42
    buffer_load_dwordx4 v4, s[36:39], s44 offen nt lds
    s_add_u32 s44, s44, s41
    s_waitcnt vmcnt(3)
    s_mov_b32 m0, s45
    s_add_u32 s45, s45, s42
    buffer_load_dwordx4 v4, s[36:39], s44 offen nt lds
L_VP_done:
    s_waitcnt lgkmcnt(0)
    s_add_u32 s63, s63, 1
    s_and_b32 s63, s63, 0xff
    v_mov_b32 v31, s63
    s_getreg_b32 s11, hwreg(HW_REG_XCC_ID, 0, 4)
    s_mul_i32 s91, s63, 0x01010100
    s_or_b32 s11, s11, s91
    s_lshl_b32 s10, s57, 7
    s_add_u32 s10, s10, 917504
    s_waitcnt vmcnt(0)
    s_sub_u32 s91, s58, 11
    s_cmp_lt_u32 s91, 16
    s_cbranch_scc1 L_noxr
    v_and_b32 v5, 31, v1
    v_lshlrev_b32 v5, 2, v5
    buffer_load_dword v5, v5, s[32:35], s10 offen sc1
L_noxr:
    v_mov_b32 v24, 0x3f803f80
    v_mov_b32 v25, 0x3f803f80
    v_min_u32 v2, 151, v0
    v_lshlrev_b32 v2, 3, v2
    v_add_u32 v2, 115456, v2
    ds_write_b64 v2, v[24:25]
    v_mov_b32 v2, 130608
    v_mov_b32 v3, 0
    ds_write_b32 v2, v3
    v_and_b32 v10, 3, v1
    v_lshlrev_b32 v13, 12, v10
    v_mul_u32_u24 v10, 1216, v10
    v_lshrrev_b32 v28, 4, v1
    v_lshl_add_u32 v10, v28, 4, v10
    v_add_u32 v10, 110592, v10
    s_and_b32 s90, s56, 1
    s_lshl_b32 s90, s90, 6
    s_lshr_b32 s91, s56, 1
    s_mul_i32 s91, s91, 18432
    v_xor_b32 v8, s90, v7
    v_add3_u32 v8, v8, v6, s91
    v_xor_b32 v9, 32, v8
    v_lshrrev_b32 v26, 2, v1
    v_lshlrev_b32 v26, 7, v26
    v_and_b32 v29, 3, v1
    v_lshl_add_u32 v26, v29, 3, v26
    v_bfe_u32 v27, v1, 3, 1
    v_bfe_u32 v29, v1, 5, 1
    v_lshl_add_u32 v27, v29, 1, v27
    v_lshlrev_b32 v27, 5, v27
    v_xor_b32 v27, s90, v27
    v_add3_u32 v26, v26, v27, s91
    v_xor_b32 v27, 32, v26
    s_lshr_b32 s91, s83, 2
    s_mul_i32 s90, s91, 288
    v_add_u32 v12, s90, v10
    v_lshlrev_b32 v11, 3, v28
    v_sub_u32 v11, v12, v11
    v_lshl_add_u32 v13, v28, 4, v13
    v_bfe_u32 v29, v1, 2, 1
    v_lshl_add_u32 v13, v29, 6, v13
    v_and_b32 v29, 8, v1
    v_lshl_add_u32 v13, v29, 27, v13
    s_lshl_b32 s90, s91, 10
    s_bfe_u32 s91, s83, 0x10001
    s_lshl_b32 s91, s91, 14
    s_add_u32 s90, s90, s91
    s_and_b32 s91, s83, 1
    s_lshl2_add_u32 s91, s91, s56
    s_lshl_b32 s91, s91, 7
    s_add_u32 s90, s90, s91
    s_add_u32 s90, s90, s82
    s_waitcnt lgkmcnt(0)
    s_barrier
    s_sub_u32 s91, s58, 11
    s_cmp_lt_u32 s91, 16
    s_cbranch_scc1 L_noq
    ds_read_b64_tr_b16 v[32:33], v8 offset:0
    ds_read_b64_tr_b16 v[34:35], v8 offset:512
    ds_read_b64_tr_b16 v[52:53], v9 offset:0
    ds_read_b64_tr_b16 v[54:55], v9 offset:512
    ds_read_b128 v[72:75], v12 offset:0
    ds_read_b64_tr_b16 v[36:37], v8 offset:4096
    ds_read_b64_tr_b16 v[38:39], v8 offset:4608
    ds_read_b64_tr_b16 v[56:57], v9 offset:4096
    ds_read_b64_tr_b16 v[58:59], v9 offset:4608
    ds_read_b128 v[76:79], v12 offset:64
    ds_read_b64_tr_b16 v[40:41], v8 offset:8192
    ds_read_b64_tr_b16 v[42:43], v8 offset:8704
    ds_read_b64_tr_b16 v[60:61], v9 offset:8192
    ds_read_b64_tr_b16 v[62:63], v9 offset:8704
    ds_read_b128 v[80:83], v12 offset:128
    ds_read_b64_tr_b16 v[44:45], v8 offset:12288
    ds_read_b64_tr_b16 v[46:47], v8 offset:12800
    ds_read_b64_tr_b16 v[64:65], v9 offset:12288
    ds_read_b64_tr_b16 v[66:67], v9 offset:12800
    ds_read_b128 v[84:87], v12 offset:192
    ds_read_b64_tr_b16 v[48:49], v26 offset:16384
    ds_read_b64_tr_b16 v[68:69], v27 offset:16384
    ds_read_b64 v[88:89], v11 offset:256
    s_waitcnt lgkmcnt(0)
    v_mfma_f32_16x16x32_bf16 v[96:99], v[32:35], v[72:75], 0
    v_mfma_f32_16x16x32_bf16 v[100:103], v[52:55], v[72:75], 0
    v_mfma_f32_16x16x32_bf16 v[96:99], v[36:39], v[76:79], v[96:99]
    v_mfma_f32_16x16x32_bf16 v[100:103], v[56:59], v[76:79], v[100:103]
    v_mfma_f32_16x16x32_bf16 v[96:99], v[40:43], v[80:83], v[96:99]
    v_mfma_f32_16x16x32_bf16 v[100:103], v[60:63], v[80:83], v[100:103]
    v_mfma_f32_16x16x32_bf16 v[96:99], v[44:47], v[84:87], v[96:99]
    v_mfma_f32_16x16x32_bf16 v[100:103], v[64:67], v[84:87], v[100:103]
    s_nop 7
    v_mfma_f32_16x16x16_bf16 v[96:99], v[48:49], v[88:89], v[96:99]
    v_mfma_f32_16x16x16_bf16 v[100:103], v[68:69], v[88:89], v[100:103]
    s_waitcnt vmcnt(0)
    v_cmp_ne_u32 vcc, s11, v5
    s_nop 0
    s_cmp_eq_u64 vcc, 0
    s_cselect_b32 s89, 1, 0
    s_nop 2
    v_mov_b32_dpp v96, v100 quad_perm:[0,1,2,3] row_mask:0xf bank_mask:0x2
    v_mov_b32_dpp v97, v101 quad_perm:[0,1,2,3] row_mask:0xf bank_mask:0x2
    v_mov_b32_dpp v98, v102 quad_perm:[0,1,2,3] row_mask:0xf bank_mask:0x2
    v_mov_b32_dpp v99, v103 quad_perm:[0,1,2,3] row_mask:0xf bank_mask:0x2
    s_bfe_u32 s91, s63, 0x20006
    v_and_or_b32 v96, v96, -4, s91
    s_bfe_u32 s91, s63, 0x20004
    v_and_or_b32 v97, v97, -4, s91
    s_bfe_u32 s91, s63, 0x20002
    v_and_or_b32 v98, v98, -4, s91
    s_bfe_u32 s91, s63, 0x20000
    v_and_or_b32 v99, v99, -4, s91
    s_cmp_eq_u32 s89, 0
    s_cbranch_scc1 L_qst_s
    buffer_store_dwordx4 v[96:99], v13, s[32:35], s90 offen
L_qst_d:
L_noq:
    v_lshrrev_b32 v28, 4, v1
    v_and_b32 v29, 15, v1
    v_lshlrev_b32 v13, 10, v28
    v_lshl_add_u32 v13, v29, 4, v13
    s_lshl_b32 s15, s58, 10
    s_and_b32 s14, s15, 0x7000
    s_add_u32 s15, s15, s82
    s_lshl_b32 s91, s56, 8
    s_add_u32 s14, s14, s91
    s_add_u32 s14, s14, s82
    v_lshlrev_b32 v14, 3, v29
    v_lshl_add_u32 v14, v28, 1, v14
    s_lshr_b32 s91, s56, 1
    s_mul_i32 s91, s91, 384
    s_and_b32 s92, s56, 1
    s_lshl_b32 s92, s92, 7
    s_add_u32 s91, s91, s92
    s_add_u32 s91, s91, 116672
    v_add_u32 v14, s91, v14
    v_lshrrev_b32 v17, 5, v1
    v_lshlrev_b32 v17, 3, v17
    v_add_u32 v17, 122048, v17
    v_and_b32 v15, 1, v1
    v_cmp_eq_u32 vcc, 1, v15
    v_mov_b32 v16, 0xffff
    v_mov_b32 v18, s88
    v_cndmask_b32 v16, v16, v18, vcc
    v_bfe_u32 v15, v1, 1, 2
    v_cmp_eq_u32 vcc, 0, v15
    s_nop 1
    v_cndmask_b32 v200, 0, v16, vcc
    v_cmp_eq_u32 vcc, 1, v15
    s_nop 1
    v_cndmask_b32 v201, 0, v16, vcc
    v_cmp_eq_u32 vcc, 2, v15
    s_nop 1
    v_cndmask_b32 v202, 0, v16, vcc
    v_cmp_eq_u32 vcc, 3, v15
    s_nop 1
    v_cndmask_b32 v203, 0, v16, vcc
    v_bfe_u32 v15, v1, 3, 1
    v_mul_u32_u24 v15, 576, v15
    v_mul_u32_u24 v16, 144, v28
    s_mul_i32 s91, s56, 1152
    s_add_u32 s91, s91, 117440
    v_add3_u32 v15, v15, v16, s91
    v_lshlrev_b32 v16, 4, v1
    s_lshl_b32 s91, s56, 10
    v_add_u32 v19, 122112, v16
    v_add_u32 v18, s91, v19
    v_mov_b32 v24, 130608
    v_mov_b32 v25, 1
    v_add_u32 v27, 66, v31
    v_and_b32 v27, 0xff, v27
    s_lshl_b32 s91, s56, 4
    v_add_u32 v23, s91, v17
    s_mov_b32 s44, s20
    s_mov_b32 s45, s21
    s_mov_b32 s46, 5308416
    s_mov_b32 s47, 0x20000
    v_mov_b32 v216, 0
    v_mov_b32 v220, 0
    v_mov_b32 v223, 0
    s_cmp_ge_u32 s84, 9
    s_cbranch_scc1 L_nowo
    s_lshl3_add_u32 s85, s84, s86
    s_mov_b32 s48, s4
    s_mov_b32 s49, s5
    s_mov_b32 s50, 4608
    s_mov_b32 s51, 0x20000
    v_bfe_u32 v223, v1, 2, 1
    v_mul_u32_u24 v223, 1152, v223
    v_and_b32 v28, 3, v1
    v_lshl_add_u32 v223, v28, 3, v223
    v_lshrrev_b32 v28, 4, v1
    v_lshl_add_u32 v223, v28, 1, v223
    s_and_b32 s90, s85, 1
    s_mul_i32 s90, s90, 2304
    s_lshr_b32 s91, s85, 1
    s_lshl_b32 s91, s91, 5
    s_add_u32 s90, s90, s91
    v_add_u32 v223, s90, v223
    v_mov_b32 v219, 0
    buffer_load_short_d16_hi v219, v223, s[48:51], 0 offen
    v_lshlrev_b32 v216, 4, v1
    v_lshrrev_b32 v29, 5, v1
    s_lshr_b32 s91, s86, 2
    s_mul_i32 s90, s56, 1088
    s_lshl_b32 s91, s91, 9
    s_add_u32 s90, s90, s91
    s_add_u32 s90, s90, 126208
    v_lshl_add_u32 v218, v29, 8, s90
    v_and_b32 v29, 15, v1
    v_lshl_add_u32 v218, v29, 4, v218
    v_bfe_u32 v29, v1, 4, 1
    v_lshl_add_u32 v218, v29, 3, v218
    v_and_b32 v222, 7, v1
    v_lshlrev_b32 v222, 4, v222
    v_lshl_add_u32 v220, v28, 2, v222
    v_lshlrev_b32 v220, 1, v223
    v_and_b32 v29, 8, v1
    v_lshlrev_b32 v29, 27, v29
    v_or_b32 v220, v220, v29
    v_or_b32 v223, v223, v29
    s_mul_i32 s92, s63, 0x101
    v_mov_b32 v221, s92
    s_lshl_b32 s16, s86, 12
    s_add_u32 s16, s16, s82
    s_lshl_b32 s17, s85, 10
    s_add_u32 s17, s17, 491520
    s_mul_i32 s18, s57, 9216
    s_add_u32 s18, s18, 294912
    s_lshl_b32 s90, s57, 3
    s_bfm_b64 s[94:95], 8, s90
    s_lshl_b32 s90, s86, 7
    s_add_u32 s90, s90, 130624
    v_add_u32 v222, s90, v222
L_nowo:
    s_barrier
    v_and_b32 v5, 31, v1
    v_lshlrev_b32 v5, 2, v5
    buffer_load_dword v5, v5, s[32:35], s10 offen sc1
    s_add_u32 s3, s63, 0
    s_mov_b32 s81, 0
    buffer_load_dwordx4 v[208:211], v13, s[32:35], s14 offen sc1
    s_and_b32 s93, s80, 24
    s_and_b32 s90, s80, 7
    s_lshl2_add_u32 s90, s93, s90
    s_lshl_b32 s90, s90, 12
    buffer_load_dwordx4 v[32:35], v16, s[28:31], s90 offen offset:0 nt
    buffer_load_dwordx4 v[36:39], v16, s[28:31], s90 offen offset:1024 nt
    buffer_load_dwordx4 v[40:43], v16, s[28:31], s90 offen offset:2048 nt
    buffer_load_dwordx4 v[44:47], v16, s[28:31], s90 offen offset:3072 nt
    s_add_u32 s90, s80, 4
    s_and_b32 s93, s90, 24
    s_and_b32 s90, s90, 7
    s_lshl2_add_u32 s90, s93, s90
    s_lshl_b32 s90, s90, 12
    buffer_load_dwordx4 v[48:51], v16, s[28:31], s90 offen offset:0 nt
    buffer_load_dwordx4 v[52:55], v16, s[28:31], s90 offen offset:1024 nt
    s_waitcnt vmcnt(6)
L_pq_c:
    v_and_b32 v30, 3, v208
    v_lshlrev_b32 v30, 2, v30
    v_and_or_b32 v30, v209, 3, v30
    v_lshlrev_b32 v30, 2, v30
    v_and_or_b32 v30, v210, 3, v30
    v_lshlrev_b32 v30, 2, v30
    v_and_or_b32 v30, v211, 3, v30
    v_cmp_ne_u32 vcc, s3, v30
    s_cbranch_vccz L_pq_x
    buffer_load_dwordx4 v[208:211], v13, s[32:35], s14 offen sc1
    s_add_u32 s81, s81, 1
    s_cmp_le_u32 s81, 1048576
    s_waitcnt vmcnt(0)
    s_cbranch_scc1 L_pq_c
L_pq_x:
    v_and_b32 v208, -4, v208
    v_and_b32 v209, -4, v209
    v_and_b32 v210, -4, v210
    v_and_b32 v211, -4, v211
    s_nop 0
    v_permlane32_swap_b32 v208, v210
    v_permlane32_swap_b32 v209, v211
    v_pk_add_f32 v[208:209], v[208:209], v[210:211]
    s_nop 1
    v_permlane16_swap_b32 v208, v209
    v_add_f32 v208, v208, v209
    v_cvt_pk_bf16_f32 v208, v208, v208
    ds_write_b16 v14, v208
    s_waitcnt lgkmcnt(0)
    s_barrier
    v_cmp_ne_u32 vcc, s11, v5
    s_nop 0
    s_cmp_eq_u64 vcc, 0
    s_cselect_b32 s89, 1, 0
    s_mov_b32 s9, 11
    s_mov_b32 s91, 133955584
    s_bitcmp1_b32 s91, s58
    s_cselect_b32 s9, 12, s9
    s_mov_b32 s91, 210944
    s_bitcmp1_b32 s91, s58
    s_cselect_b32 s9, 10, s9
    s_mov_b32 s91, 49152
    s_cmp_eq_u32 s57, 3
    s_cselect_b32 s91, 245760, s91
    s_bitcmp1_b32 s91, s58
    s_cselect_b32 s9, 14, s9
    s_cmp_ge_u32 s9, 14
    s_cbranch_scc1 L_vb6
    s_waitcnt vmcnt(5)
    s_cmp_ge_u32 s9, 12
    s_cbranch_scc1 L_vb6
    s_waitcnt vmcnt(4)
L_vb6:
    buffer_load_dwordx4 v[56:59], v16, s[28:31], s90 offen offset:2048 nt
    s_waitcnt vmcnt(6)
    s_cmp_ge_u32 s9, 13
    s_cbranch_scc1 L_vb7
    s_waitcnt vmcnt(5)
    s_cmp_ge_u32 s9, 11
    s_cbranch_scc1 L_vb7
    s_waitcnt vmcnt(4)
L_vb7:
    buffer_load_dwordx4 v[60:63], v16, s[28:31], s90 offen offset:3072 nt
    s_waitcnt vmcnt(6)
    s_cmp_ge_u32 s9, 14
    s_cbranch_scc1 L_vb8
    s_waitcnt vmcnt(5)
    s_cmp_ge_u32 s9, 12
    s_cbranch_scc1 L_vb8
    s_waitcnt vmcnt(4)
L_vb8:
    s_add_u32 s90, s80, 8
    s_and_b32 s93, s90, 24
    s_and_b32 s90, s90, 7
    s_lshl2_add_u32 s90, s93, s90
    s_lshl_b32 s90, s90, 12
    buffer_load_dwordx4 v[64:67], v16, s[28:31], s90 offen offset:0 nt
    s_waitcnt vmcnt(6)
    s_cmp_ge_u32 s9, 13
    s_cbranch_scc1 L_vb9
    s_waitcnt vmcnt(5)
    s_cmp_ge_u32 s9, 11
    s_cbranch_scc1 L_vb9
    s_waitcnt vmcnt(4)
L_vb9:
    buffer_load_dwordx4 v[68:71], v16, s[28:31], s90 offen offset:1024 nt
    s_barrier
    ds_read_b128 v[160:163], v15 offset:0
    ds_read_b128 v[164:167], v15 offset:16
    ds_read_b128 v[168:171], v15 offset:32
    ds_read_b128 v[172:175], v15 offset:48
    ds_read_b128 v[176:179], v15 offset:64
    ds_read_b128 v[180:183], v15 offset:80
    ds_read_b128 v[184:187], v15 offset:96
    ds_read_b128 v[188:191], v15 offset:112
    ds_read_b32 v22, v23
    s_waitcnt vmcnt(6)
    s_cmp_ge_u32 s9, 14
    s_cbranch_scc1 L_vb10
    s_waitcnt vmcnt(5)
    s_cmp_ge_u32 s9, 12
    s_cbranch_scc1 L_vb10
    s_waitcnt vmcnt(4)
L_vb10:
    buffer_load_dwordx4 v[72:75], v16, s[28:31], s90 offen offset:2048 nt
    s_waitcnt lgkmcnt(0)
    s_waitcnt vmcnt(6)
    s_cmp_ge_u32 s9, 13
    s_cbranch_scc1 L_vb11
    s_waitcnt vmcnt(5)
    s_cmp_ge_u32 s9, 11
    s_cbranch_scc1 L_vb11
    s_waitcnt vmcnt(4)
L_vb11:
    buffer_load_dwordx4 v[76:79], v16, s[28:31], s90 offen offset:3072 nt
    v_and_b32 v192, v160, v200
    v_and_b32 v193, v160, v201
    v_and_b32 v194, v160, v202
    v_and_b32 v195, v160, v203
    s_nop 1
    v_mfma_f32_16x16x32_bf16 v[204:207], v[192:195], v[32:35], 0
    v_and_b32 v196, v161, v200
    v_and_b32 v197, v161, v201
    v_and_b32 v198, v161, v202
    v_and_b32 v199, v161, v203
    s_nop 1
    v_mfma_f32_16x16x32_bf16 v[204:207], v[196:199], v[36:39], v[204:207]
    v_and_b32 v192, v162, v200
    v_and_b32 v193, v162, v201
    v_and_b32 v194, v162, v202
    v_and_b32 v195, v162, v203
    s_nop 1
    v_mfma_f32_16x16x32_bf16 v[204:207], v[192:195], v[40:43], v[204:207]
    s_waitcnt vmcnt(6)
    s_cmp_ge_u32 s9, 14
    s_cbranch_scc1 L_vb12
    s_waitcnt vmcnt(5)
    s_cmp_ge_u32 s9, 12
    s_cbranch_scc1 L_vb12
    s_waitcnt vmcnt(4)
L_vb12:
    s_add_u32 s90, s80, 12
    s_and_b32 s93, s90, 24
    s_and_b32 s90, s90, 7
    s_lshl2_add_u32 s90, s93, s90
    s_lshl_b32 s90, s90, 12
    buffer_load_dwordx4 v[80:83], v16, s[28:31], s90 offen offset:0 nt
    v_and_b32 v196, v163, v200
    v_and_b32 v197, v163, v201
    v_and_b32 v198, v163, v202
    v_and_b32 v199, v163, v203
    s_nop 1
    v_mfma_f32_16x16x32_bf16 v[204:207], v[196:199], v[44:47], v[204:207]
    v_and_b32 v192, v164, v200
    v_and_b32 v193, v164, v201
    v_and_b32 v194, v164, v202
    v_and_b32 v195, v164, v203
    s_nop 1
    v_mfma_f32_16x16x32_bf16 v[204:207], v[192:195], v[48:51], v[204:207]
    v_and_b32 v196, v165, v200
    v_and_b32 v197, v165, v201
    v_and_b32 v198, v165, v202
    v_and_b32 v199, v165, v203
    s_nop 1
    v_mfma_f32_16x16x32_bf16 v[204:207], v[196:199], v[52:55], v[204:207]
    s_waitcnt vmcnt(6)
    s_cmp_ge_u32 s9, 13
    s_cbranch_scc1 L_vb13
    s_waitcnt vmcnt(5)
    s_cmp_ge_u32 s9, 11
    s_cbranch_scc1 L_vb13
    s_waitcnt vmcnt(4)
L_vb13:
    buffer_load_dwordx4 v[84:87], v16, s[28:31], s90 offen offset:1024 nt
    v_and_b32 v192, v166, v200
    v_and_b32 v193, v166, v201
    v_and_b32 v194, v166, v202
    v_and_b32 v195, v166, v203
    s_nop 1
    v_mfma_f32_16x16x32_bf16 v[204:207], v[192:195], v[56:59], v[204:207]
    s_waitcnt vmcnt(6)
    s_cmp_ge_u32 s9, 14
    s_cbranch_scc1 L_vb14
    s_waitcnt vmcnt(5)
    s_cmp_ge_u32 s9, 12
    s_cbranch_scc1 L_vb14
    s_waitcnt vmcnt(4)
L_vb14:
    buffer_load_dwordx4 v[88:91], v16, s[28:31], s90 offen offset:2048 nt
    v_and_b32 v196, v167, v200
    v_and_b32 v197, v167, v201
    v_and_b32 v198, v167, v202
    v_and_b32 v199, v167, v203
    s_nop 1
    v_mfma_f32_16x16x32_bf16 v[204:207], v[196:199], v[60:63], v[204:207]
    s_waitcnt vmcnt(6)
    s_cmp_ge_u32 s9, 13
    s_cbranch_scc1 L_vb15
    s_waitcnt vmcnt(5)
    s_cmp_ge_u32 s9, 11
    s_cbranch_scc1 L_vb15
    s_waitcnt vmcnt(4)
L_vb15:
    buffer_load_dwordx4 v[92:95], v16, s[28:31], s90 offen offset:3072 nt
    v_and_b32 v192, v168, v200
    v_and_b32 v193, v168, v201
    v_and_b32 v194, v168, v202
    v_and_b32 v195, v168, v203
    s_nop 1
    v_mfma_f32_16x16x32_bf16 v[204:207], v[192:195], v[64:67], v[204:207]
    s_waitcnt vmcnt(6)
    s_cmp_ge_u32 s9, 14
    s_cbranch_scc1 L_vb16
    s_waitcnt vmcnt(5)
    s_cmp_ge_u32 s9, 12
    s_cbranch_scc1 L_vb16
    s_waitcnt vmcnt(4)
L_vb16:
    s_add_u32 s90, s80, 16
    s_and_b32 s93, s90, 24
    s_and_b32 s90, s90, 7
    s_lshl2_add_u32 s90, s93, s90
    s_lshl_b32 s90, s90, 12
    buffer_load_dwordx4 v[96:99], v16, s[28:31], s90 offen offset:0 nt
    v_and_b32 v196, v169, v200
    v_and_b32 v197, v169, v201
    v_and_b32 v198, v169, v202
    v_and_b32 v199, v169, v203
    s_nop 1
    v_mfma_f32_16x16x32_bf16 v[204:207], v[196:199], v[68:71], v[204:207]
    s_waitcnt vmcnt(6)
    s_cmp_ge_u32 s9, 13
    s_cbranch_scc1 L_vb17
    s_waitcnt vmcnt(5)
    s_cmp_ge_u32 s9, 11
    s_cbranch_scc1 L_vb17
    s_waitcnt vmcnt(4)
L_vb17:
    buffer_load_dwordx4 v[100:103], v16, s[28:31], s90 offen offset:1024 nt
    v_and_b32 v192, v170, v200
    v_and_b32 v193, v170, v201
    v_and_b32 v194, v170, v202
    v_and_b32 v195, v170, v203
    s_nop 1
    v_mfma_f32_16x16x32_bf16 v[204:207], v[192:195], v[72:75], v[204:207]
    s_waitcnt vmcnt(6)
    s_cmp_ge_u32 s9, 14
    s_cbranch_scc1 L_vb18
    s_waitcnt vmcnt(5)
    s_cmp_ge_u32 s9, 12
    s_cbranch_scc1 L_vb18
    s_waitcnt vmcnt(4)
L_vb18:
    buffer_load_dwordx4 v[104:107], v16, s[28:31], s90 offen offset:2048 nt
    v_and_b32 v196, v171, v200
    v_and_b32 v197, v171, v201
    v_and_b32 v198, v171, v202
    v_and_b32 v199, v171, v203
    s_nop 1
    v_mfma_f32_16x16x32_bf16 v[204:207], v[196:199], v[76:79], v[204:207]
    s_waitcnt vmcnt(6)
    s_cmp_ge_u32 s9, 13
    s_cbranch_scc1 L_vb19
    s_waitcnt vmcnt(5)
    s_cmp_ge_u32 s9, 11
    s_cbranch_scc1 L_vb19
    s_waitcnt vmcnt(4)
L_vb19:
    buffer_load_dwordx4 v[108:111], v16, s[28:31], s90 offen offset:3072 nt
    v_and_b32 v192, v172, v200
    v_and_b32 v193, v172, v201
    v_and_b32 v194, v172, v202
    v_and_b32 v195, v172, v203
    s_nop 1
    v_mfma_f32_16x16x32_bf16 v[204:207], v[192:195], v[80:83], v[204:207]
    s_waitcnt vmcnt(6)
    s_cmp_ge_u32 s9, 14
    s_cbranch_scc1 L_vb20
    s_waitcnt vmcnt(5)
    s_cmp_ge_u32 s9, 12
    s_cbranch_scc1 L_vb20
    s_waitcnt vmcnt(4)
L_vb20:
    s_add_u32 s90, s80, 20
    s_and_b32 s93, s90, 24
    s_and_b32 s90, s90, 7
    s_lshl2_add_u32 s90, s93, s90
    s_lshl_b32 s90, s90, 12
    buffer_load_dwordx4 v[112:115], v16, s[28:31], s90 offen offset:0 nt
    v_and_b32 v196, v173, v200
    v_and_b32 v197, v173, v201
    v_and_b32 v198, v173, v202
    v_and_b32 v199, v173, v203
    s_nop 1
    v_mfma_f32_16x16x32_bf16 v[204:207], v[196:199], v[84:87], v[204:207]
    s_waitcnt vmcnt(6)
    s_cmp_ge_u32 s9, 13
    s_cbranch_scc1 L_vb21
    s_waitcnt vmcnt(5)
    s_cmp_ge_u32 s9, 11
    s_cbranch_scc1 L_vb21
    s_waitcnt vmcnt(4)
L_vb21:
    buffer_load_dwordx4 v[116:119], v16, s[28:31], s90 offen offset:1024 nt
    v_and_b32 v192, v174, v200
    v_and_b32 v193, v174, v201
    v_and_b32 v194, v174, v202
    v_and_b32 v195, v174, v203
    s_nop 1
    v_mfma_f32_16x16x32_bf16 v[204:207], v[192:195], v[88:91], v[204:207]
    s_waitcnt vmcnt(6)
    s_cmp_ge_u32 s9, 14
    s_cbranch_scc1 L_vb22
    s_waitcnt vmcnt(5)
    s_cmp_ge_u32 s9, 12
    s_cbranch_scc1 L_vb22
    s_waitcnt vmcnt(4)
L_vb22:
    buffer_load_dwordx4 v[120:123], v16, s[28:31], s90 offen offset:2048 nt
    v_and_b32 v196, v175, v200
    v_and_b32 v197, v175, v201
    v_and_b32 v198, v175, v202
    v_and_b32 v199, v175, v203
    s_nop 1
    v_mfma_f32_16x16x32_bf16 v[204:207], v[196:199], v[92:95], v[204:207]
    s_waitcnt vmcnt(6)
    s_cmp_ge_u32 s9, 13
    s_cbranch_scc1 L_vb23
    s_waitcnt vmcnt(5)
    s_cmp_ge_u32 s9, 11
    s_cbranch_scc1 L_vb23
    s_waitcnt vmcnt(4)
L_vb23:
    buffer_load_dwordx4 v[124:127], v16, s[28:31], s90 offen offset:3072 nt
    v_and_b32 v192, v176, v200
    v_and_b32 v193, v176, v201
    v_and_b32 v194, v176, v202
    v_and_b32 v195, v176, v203
    s_nop 1
    v_mfma_f32_16x16x32_bf16 v[204:207], v[192:195], v[96:99], v[204:207]
    s_waitcnt vmcnt(6)
    s_cmp_ge_u32 s9, 14
    s_cbranch_scc1 L_vb24
    s_waitcnt vmcnt(5)
    s_cmp_ge_u32 s9, 12
    s_cbranch_scc1 L_vb24
    s_waitcnt vmcnt(4)
L_vb24:
    s_add_u32 s90, s80, 24
    s_and_b32 s93, s90, 24
    s_and_b32 s90, s90, 7
    s_lshl2_add_u32 s90, s93, s90
    s_lshl_b32 s90, s90, 12
    buffer_load_dwordx4 v[128:131], v16, s[28:31], s90 offen offset:0 nt
    v_and_b32 v196, v177, v200
    v_and_b32 v197, v177, v201
    v_and_b32 v198, v177, v202
    v_and_b32 v199, v177, v203
    s_nop 1
    v_mfma_f32_16x16x32_bf16 v[204:207], v[196:199], v[100:103], v[204:207]
    s_waitcnt vmcnt(6)
    s_cmp_ge_u32 s9, 13
    s_cbranch_scc1 L_vb25
    s_waitcnt vmcnt(5)
    s_cmp_ge_u32 s9, 11
    s_cbranch_scc1 L_vb25
    s_waitcnt vmcnt(4)
L_vb25:
    buffer_load_dwordx4 v[132:135], v16, s[28:31], s90 offen offset:1024 nt
    v_and_b32 v192, v178, v200
    v_and_b32 v193, v178, v201
    v_and_b32 v194, v178, v202
    v_and_b32 v195, v178, v203
    s_nop 1
    v_mfma_f32_16x16x32_bf16 v[204:207], v[192:195], v[104:107], v[204:207]
    s_waitcnt vmcnt(6)
    s_cmp_ge_u32 s9, 14
    s_cbranch_scc1 L_vb26
    s_waitcnt vmcnt(5)
    s_cmp_ge_u32 s9, 12
    s_cbranch_scc1 L_vb26
    s_waitcnt vmcnt(4)
L_vb26:
    buffer_load_dwordx4 v[136:139], v16, s[28:31], s90 offen offset:2048 nt
    v_and_b32 v196, v179, v200
    v_and_b32 v197, v179, v201
    v_and_b32 v198, v179, v202
    v_and_b32 v199, v179, v203
    s_nop 1
    v_mfma_f32_16x16x32_bf16 v[204:207], v[196:199], v[108:111], v[204:207]
    s_waitcnt vmcnt(6)
    s_cmp_ge_u32 s9, 13
    s_cbranch_scc1 L_vb27
    s_waitcnt vmcnt(5)
    s_cmp_ge_u32 s9, 11
    s_cbranch_scc1 L_vb27
    s_waitcnt vmcnt(4)
L_vb27:
    buffer_load_dwordx4 v[140:143], v16, s[28:31], s90 offen offset:3072 nt
    v_and_b32 v192, v180, v200
    v_and_b32 v193, v180, v201
    v_and_b32 v194, v180, v202
    v_and_b32 v195, v180, v203
    s_nop 1
    v_mfma_f32_16x16x32_bf16 v[204:207], v[192:195], v[112:115], v[204:207]
    s_waitcnt vmcnt(6)
    s_cmp_ge_u32 s9, 14
    s_cbranch_scc1 L_vb28
    s_waitcnt vmcnt(5)
    s_cmp_ge_u32 s9, 12
    s_cbranch_scc1 L_vb28
    s_waitcnt vmcnt(4)
L_vb28:
    s_add_u32 s90, s80, 28
    s_and_b32 s93, s90, 24
    s_and_b32 s90, s90, 7
    s_lshl2_add_u32 s90, s93, s90
    s_lshl_b32 s90, s90, 12
    buffer_load_dwordx4 v[144:147], v16, s[28:31], s90 offen offset:0 nt
    v_and_b32 v196, v181, v200
    v_and_b32 v197, v181, v201
    v_and_b32 v198, v181, v202
    v_and_b32 v199, v181, v203
    s_nop 1
    v_mfma_f32_16x16x32_bf16 v[204:207], v[196:199], v[116:119], v[204:207]
    buffer_load_dwordx4 v[148:151], v16, s[28:31], s90 offen offset:1024 nt
    buffer_load_dwordx4 v[152:155], v16, s[28:31], s90 offen offset:2048 nt
    buffer_load_dwordx4 v[156:159], v16, s[28:31], s90 offen offset:3072 nt
    s_barrier
    ds_read_b64 v[20:21], v17 offset:8512
    v_and_b32 v192, v182, v200
    v_and_b32 v193, v182, v201
    v_and_b32 v194, v182, v202
    v_and_b32 v195, v182, v203
    s_waitcnt vmcnt(9)
    s_nop 0
    v_mfma_f32_16x16x32_bf16 v[204:207], v[192:195], v[120:123], v[204:207]
    v_and_b32 v196, v183, v200
    v_and_b32 v197, v183, v201
    v_and_b32 v198, v183, v202
    v_and_b32 v199, v183, v203
    s_waitcnt vmcnt(8)
    s_nop 0
    v_mfma_f32_16x16x32_bf16 v[204:207], v[196:199], v[124:127], v[204:207]
    v_and_b32 v192, v184, v200
    v_and_b32 v193, v184, v201
    v_and_b32 v194, v184, v202
    v_and_b32 v195, v184, v203
    s_waitcnt vmcnt(7)
    s_nop 0
    v_mfma_f32_16x16x32_bf16 v[204:207], v[192:195], v[128:131], v[204:207]
    v_and_b32 v196, v185, v200
    v_and_b32 v197, v185, v201
    v_and_b32 v198, v185, v202
    v_and_b32 v199, v185, v203
    s_waitcnt vmcnt(6)
    s_nop 0
    v_mfma_f32_16x16x32_bf16 v[204:207], v[196:199], v[132:135], v[204:207]
    v_and_b32 v192, v186, v200
    v_and_b32 v193, v186, v201
    v_and_b32 v194, v186, v202
    v_and_b32 v195, v186, v203
    s_waitcnt vmcnt(5)
    s_nop 0
    v_mfma_f32_16x16x32_bf16 v[204:207], v[192:195], v[136:139], v[204:207]
    v_and_b32 v196, v187, v200
    v_and_b32 v197, v187, v201
    v_and_b32 v198, v187, v202
    v_and_b32 v199, v187, v203
    s_waitcnt vmcnt(4)
    s_nop 0
    v_mfma_f32_16x16x32_bf16 v[204:207], v[196:199], v[140:143], v[204:207]
    v_and_b32 v192, v188, v200
    v_and_b32 v193, v188, v201
    v_and_b32 v194, v188, v202
    v_and_b32 v195, v188, v203
    s_waitcnt vmcnt(3)
    s_nop 0
    v_mfma_f32_16x16x32_bf16 v[204:207], v[192:195], v[144:147], v[204:207]
    v_and_b32 v196, v189, v200
    v_and_b32 v197, v189, v201
    v_and_b32 v198, v189, v202
    v_and_b32 v199, v189, v203
    s_waitcnt vmcnt(2)
    s_nop 0
    v_mfma_f32_16x16x32_bf16 v[204:207], v[196:199], v[148:151], v[204:207]
    v_and_b32 v192, v190, v200
    v_and_b32 v193, v190, v201
    v_and_b32 v194, v190, v202
    v_and_b32 v195, v190, v203
    s_waitcnt lgkmcnt(0)
    v_sub_f32 v22, v22, v20
    v_mul_f32 v22, 1069066811, v22
    v_exp_f32 v22, v22
    s_nop 0
    v_mul_f32 v22, v22, v21
    s_waitcnt vmcnt(1)
    v_mfma_f32_16x16x32_bf16 v[204:207], v[192:195], v[152:155], v[204:207]
    v_and_b32 v196, v191, v200
    v_and_b32 v197, v191, v201
    v_and_b32 v198, v191, v202
    v_and_b32 v199, v191, v203
    s_waitcnt vmcnt(0)
    s_nop 0
    v_mfma_f32_16x16x32_bf16 v[204:207], v[196:199], v[156:159], v[204:207]
    s_nop 7
    v_pk_mul_f32 v[204:205], v[204:205], v[22:23] op_sel_hi:[1,0]
    v_pk_mul_f32 v[206:207], v[206:207], v[22:23] op_sel_hi:[1,0]
    ds_write_b128 v18, v[204:207]
    s_mov_b64 exec, 1
    ds_add_rtn_u32 v26, v24, v25
    s_mov_b64 exec, -1
    ds_read_b128 v[32:35], v19 offset:0
    ds_read_b128 v[36:39], v19 offset:1024
    ds_read_b128 v[40:43], v19 offset:2048
    ds_read_b128 v[44:47], v19 offset:3072
    s_waitcnt lgkmcnt(4)
    v_readfirstlane_b32 s90, v26
    s_nop 0
    s_cmp_lg_u32 s90, 3
    s_cbranch_scc1 L_V_hold
    s_cmp_eq_u32 s89, 0
    s_waitcnt lgkmcnt(2)
    v_pk_add_f32 v[32:33], v[32:33], v[36:37]
    v_pk_add_f32 v[34:35], v[34:35], v[38:39]
    s_waitcnt lgkmcnt(1)
    v_pk_add_f32 v[32:33], v[32:33], v[40:41]
    v_pk_add_f32 v[34:35], v[34:35], v[42:43]
    s_waitcnt lgkmcnt(0)
    v_pk_add_f32 v[32:33], v[32:33], v[44:45]
    v_pk_add_f32 v[34:35], v[34:35], v[46:47]
    v_and_or_b32 v35, v35, s87, v27
    s_cbranch_scc1 L_ost_s
    buffer_store_dwordx4 v[32:35], v16, s[32:35], s15 offen
L_ost_d:
L_V_hold:
    s_cmp_lt_u32 s84, 9
    s_cbranch_scc1 L_wo_gather
    s_cmp_ge_u32 s58, 18
    s_cbranch_scc1 L_exit
    s_waitcnt lgkmcnt(0)
    s_barrier
    s_lshr_b32 s90, s58, 1
    s_cmp_ge_u32 s90, 3
    s_addc_u32 s91, s90, 0
    s_cmp_eq_u32 s90, 7
    s_cselect_b32 s91, 3, s91
    s_lshl3_add_u32 s91, s57, s91
    s_add_u32 s92, s57, 64
    s_cmp_eq_u32 s90, 8
    s_cselect_b32 s85, s92, s91
    v_lshrrev_b32 v28, 4, v1
    v_and_b32 v2, 0xffffffef, v6
    v_bfe_u32 v29, v1, 1, 1
    v_mul_u32_u24 v3, 36864, v29
    v_add_u32 v2, v2, v3
    s_and_b32 s90, s58, 1
    s_lshl2_add_u32 s91, s90, s56
    s_lshl_b32 s91, s91, 4
    v_lshlrev_b32 v29, 4, v29
    v_xor_b32 v29, v29, v7
    v_xor_b32 v29, s91, v29
    v_add_u32 v9, v2, v29
    v_xor_b32 v2, 64, v9
    s_mul_i32 s90, s90, 576
    v_add_u32 v10, s90, v10
    v_and_b32 v18, 7, v1
    v_lshl_add_u32 v18, v28, 3, v18
    v_lshlrev_b32 v18, 4, v18
    v_and_b32 v29, 8, v1
    v_lshl_add_u32 v19, v29, 27, v18
    s_lshl2_add_u32 s19, s58, s56
    s_lshl_b32 s19, s19, 9
    s_xor_b32 s20, s19, 2048
    s_add_u32 s19, s19, s82
    s_add_u32 s20, s20, s82
    v_add_u32 v20, 131, v31
    v_and_b32 v20, 0xff, v20
    v_cmp_gt_u32 vcc, 32, v1
    v_mov_b32 v3, 115456
    v_mov_b32 v4, 115488
    v_cndmask_b32 v3, v3, v4, vcc
    v_and_b32 v29, 12, v1
    v_cmp_eq_u32 vcc, 0, v29
    s_nop 1
    v_cndmask_b32 v10, v3, v10, vcc
    v_and_b32 v5, 3, v1
    v_lshlrev_b32 v4, 3, v5
    v_add_u32 v4, 130576, v4
    v_mov_b32 v150, 0xC0135761
    v_mov_b32 v151, 0xBDD2D3E8
    v_mov_b32 v29, 1073741824
    v_lshlrev_b32 v3, 5, v5
    v_bfe_u32 v8, v1, 4, 1
    v_lshl_add_u32 v3, v8, 4, v3
    v_lshrrev_b32 v8, 5, v1
    v_lshl_add_u32 v3, v8, 3, v3
    v_cndmask_b32 v3, v29, v3, vcc
    s_and_b32 s90, s85, 7
    s_cmp_ge_u32 s85, 64
    s_cselect_b32 s90, 8, s90
    s_and_b32 s91, s58, 1
    s_lshl1_add_u32 s90, s90, s91
    s_lshl2_add_u32 s90, s90, s56
    s_mul_i32 s16, s57, 72
    s_add_u32 s16, s16, s90
    s_lshl_b32 s16, s16, 7
    s_add_u32 s16, s16, 393216
    s_and_b32 s13, s58, 1
    s_lshr_b32 s12, s58, 1
    v_and_b32 v5, 3, v1
    v_lshrrev_b32 v28, 4, v1
    v_mul_u32_u24 v21, 832, v5
    v_lshl_add_u32 v21, v28, 4, v21
    v_add_u32 v21, 126208, v21
    s_lshl_b32 s90, s56, 5
    v_xor_b32 v22, s90, v7
    v_add_u32 v22, v22, v6
    v_add_u32 v22, 73728, v22
    v_bfe_u32 v11, v1, 1, 1
    v_mul_u32_u24 v11, 3072, v11
    v_and_b32 v8, 1, v1
    v_lshl_add_u32 v11, v8, 6, v11
    v_lshl_add_u32 v11, v28, 4, v11
    v_and_b32 v8, 12, v1
    v_lshl_add_u32 v11, v8, 26, v11
    s_lshl2_add_u32 s21, s12, s56
    s_mul_i32 s21, s21, 6144
    s_mul_i32 s90, s57, 3
    s_add_u32 s90, s90, s13
    s_lshl_b32 s90, s90, 7
    s_add_u32 s21, s21, s90
    s_add_u32 s21, s21, 589824
    s_mul_i32 s90, s63, 0x01010101
    v_mov_b32 v155, s90
    s_barrier
    ds_read_b64_tr_b16 v[32:33], v2 offset:0
    ds_read_b64_tr_b16 v[34:35], v2 offset:512
    ds_read_b64_tr_b16 v[36:37], v2 offset:4096
    ds_read_b64_tr_b16 v[38:39], v2 offset:4608
    ds_read_b64_tr_b16 v[40:41], v2 offset:8192
    ds_read_b64_tr_b16 v[42:43], v2 offset:8704
    ds_read_b64_tr_b16 v[44:45], v2 offset:12288
    ds_read_b64_tr_b16 v[46:47], v2 offset:12800
    ds_read_b64_tr_b16 v[48:49], v2 offset:16384
    ds_read_b64_tr_b16 v[50:51], v2 offset:16896
    ds_read_b64_tr_b16 v[52:53], v2 offset:20480
    ds_read_b64_tr_b16 v[54:55], v2 offset:20992
    ds_read_b64_tr_b16 v[56:57], v2 offset:24576
    ds_read_b64_tr_b16 v[58:59], v2 offset:25088
    ds_read_b64_tr_b16 v[60:61], v2 offset:28672
    ds_read_b64_tr_b16 v[62:63], v2 offset:29184
    ds_read_b64_tr_b16 v[64:65], v2 offset:32768
    ds_read_b64_tr_b16 v[66:67], v2 offset:33280
    ds_read_b64_tr_b16 v[68:69], v9 offset:0
    ds_read_b64_tr_b16 v[70:71], v9 offset:512
    ds_read_b64_tr_b16 v[72:73], v9 offset:4096
    ds_read_b64_tr_b16 v[74:75], v9 offset:4608
    ds_read_b64_tr_b16 v[76:77], v9 offset:8192
    ds_read_b64_tr_b16 v[78:79], v9 offset:8704
    ds_read_b64_tr_b16 v[80:81], v9 offset:12288
    ds_read_b64_tr_b16 v[82:83], v9 offset:12800
    ds_read_b64_tr_b16 v[84:85], v9 offset:16384
    ds_read_b64_tr_b16 v[86:87], v9 offset:16896
    ds_read_b64_tr_b16 v[88:89], v9 offset:20480
    ds_read_b64_tr_b16 v[90:91], v9 offset:20992
    ds_read_b64_tr_b16 v[92:93], v9 offset:24576
    ds_read_b64_tr_b16 v[94:95], v9 offset:25088
    ds_read_b64_tr_b16 v[96:97], v9 offset:28672
    ds_read_b64_tr_b16 v[98:99], v9 offset:29184
    ds_read_b64_tr_b16 v[100:101], v9 offset:32768
    ds_read_b64_tr_b16 v[102:103], v9 offset:33280
    s_add_u32 s3, s63, 131
    s_mov_b32 s81, 0
    s_cmp_eq_u32 s89, 0
    s_waitcnt lgkmcnt(0)
    s_barrier
    ds_read_b128 v[160:163], v10 offset:0
    ds_read_b128 v[164:167], v10 offset:64
    ds_read_b128 v[168:171], v10 offset:128
    ds_read_b128 v[172:175], v10 offset:192
    ds_read_b128 v[176:179], v10 offset:256
    ds_read_b128 v[180:183], v10 offset:320
    ds_read_b128 v[184:187], v10 offset:384
    ds_read_b128 v[188:191], v10 offset:448
    ds_read_b128 v[192:195], v10 offset:512
    s_waitcnt lgkmcnt(8)
    v_mfma_f32_16x16x32_bf16 v[144:147], v[32:35], v[160:163], 0
    s_waitcnt lgkmcnt(7)
    v_mfma_f32_16x16x32_bf16 v[144:147], v[36:39], v[164:167], v[144:147]
    s_waitcnt lgkmcnt(6)
    v_mfma_f32_16x16x32_bf16 v[144:147], v[40:43], v[168:171], v[144:147]
    s_waitcnt lgkmcnt(5)
    v_mfma_f32_16x16x32_bf16 v[144:147], v[44:47], v[172:175], v[144:147]
    s_waitcnt lgkmcnt(4)
    v_mfma_f32_16x16x32_bf16 v[144:147], v[48:51], v[176:179], v[144:147]
    s_waitcnt lgkmcnt(3)
    v_mfma_f32_16x16x32_bf16 v[144:147], v[52:55], v[180:183], v[144:147]
    s_waitcnt lgkmcnt(2)
    v_mfma_f32_16x16x32_bf16 v[144:147], v[56:59], v[184:187], v[144:147]
    s_waitcnt lgkmcnt(1)
    v_mfma_f32_16x16x32_bf16 v[144:147], v[60:63], v[188:191], v[144:147]
    s_waitcnt lgkmcnt(0)
    v_mfma_f32_16x16x32_bf16 v[144:147], v[64:67], v[192:195], v[144:147]
    v_mfma_f32_16x16x32_bf16 v[140:143], v[68:71], v[160:163], 0
    v_mfma_f32_16x16x32_bf16 v[140:143], v[72:75], v[164:167], v[140:143]
    s_nop 5
    v_and_or_b32 v147, v147, s87, v20
    s_cbranch_scc1 L_xst_s
    buffer_store_dwordx4 v[144:147], v19, s[32:35], s19 offen
L_xst_d:
    v_mfma_f32_16x16x32_bf16 v[140:143], v[76:79], v[168:171], v[140:143]
    v_mfma_f32_16x16x32_bf16 v[140:143], v[80:83], v[172:175], v[140:143]
    v_mfma_f32_16x16x32_bf16 v[140:143], v[84:87], v[176:179], v[140:143]
    v_mfma_f32_16x16x32_bf16 v[140:143], v[88:91], v[180:183], v[140:143]
    v_mfma_f32_16x16x32_bf16 v[140:143], v[92:95], v[184:187], v[140:143]
    buffer_load_dwordx4 v[200:203], v18, s[32:35], s20 offen sc1
    v_mfma_f32_16x16x32_bf16 v[140:143], v[96:99], v[188:191], v[140:143]
    v_mfma_f32_16x16x32_bf16 v[140:143], v[100:103], v[192:195], v[140:143]
    s_nop 1
    s_barrier
    ds_read_b64 v[152:153], v4
    s_waitcnt vmcnt(0)
    v_cmp_ne_u32_sdwa vcc, v203, s3 src0_sel:BYTE_0 src1_sel:BYTE_0
    v_and_b32 v203, s87, v203
    s_cbranch_vccz L_px_f0
L_px:
    buffer_load_dwordx4 v[200:203], v18, s[32:35], s20 offen sc1
    s_add_u32 s81, s81, 1
    s_cmp_gt_u32 s81, 1048576
    s_cbranch_scc1 L_px_f0
    s_waitcnt vmcnt(0)
    v_cmp_ne_u32_sdwa vcc, v203, s3 src0_sel:BYTE_0 src1_sel:BYTE_0
    v_and_b32 v203, s87, v203
    s_cbranch_vccnz L_px
L_px_f0:
    v_pk_add_f32 v[140:141], v[140:141], v[200:201]
    v_pk_add_f32 v[142:143], v[142:143], v[202:203]
L_px_x:
    s_cmp_eq_u32 s89, 0
    s_waitcnt lgkmcnt(0)
    v_fmac_f32_dpp v140, v140, v152 row_ror:12 row_mask:0xf bank_mask:0xf
    v_fmac_f32_dpp v141, v141, v152 row_ror:12 row_mask:0xf bank_mask:0xf
    v_fmac_f32_dpp v142, v142, v152 row_ror:12 row_mask:0xf bank_mask:0xf
    v_fmac_f32_dpp v143, v143, v152 row_ror:12 row_mask:0xf bank_mask:0xf
    s_nop 0
    v_permlane32_swap_b32 v140, v142
    v_permlane32_swap_b32 v141, v143
    v_pk_mul_f32 v[140:141], v[140:141], v[152:153] op_sel:[0,1] op_sel_hi:[1,1]
    v_pk_mul_f32 v[148:149], v[140:141], v[140:141]
    v_pk_fma_f32 v[148:149], v[148:149], v[150:151], v[150:151] op_sel:[0,1,0] op_sel_hi:[1,1,0]
    v_pk_mul_f32 v[148:149], v[148:149], v[140:141]
    v_exp_f32 v148, v148
    v_exp_f32 v149, v149
    v_pk_mul_f32 v[142:143], v[142:143], v[152:153] op_sel:[0,1] op_sel_hi:[1,1]
    v_pk_add_f32 v[148:149], v[148:149], 1.0 op_sel_hi:[1,0]
    v_rcp_f32 v148, v148
    v_rcp_f32 v149, v149
    s_nop 0
    v_pk_mul_f32 v[148:149], v[148:149], v[140:141]
    v_pk_mul_f32 v[148:149], v[148:149], v[142:143]
    v_cvt_pk_bf16_f32 v154, v148, v149
    s_cbranch_scc1 L_ast_s
    buffer_store_dwordx2 v[154:155], v3, s[32:35], s16 offen
L_ast_d:
    ds_read_b64_tr_b16 v[32:33], v22 offset:0
    ds_read_b64_tr_b16 v[34:35], v22 offset:512
    ds_read_b64_tr_b16 v[36:37], v22 offset:4096
    ds_read_b64_tr_b16 v[38:39], v22 offset:4608
    ds_read_b64_tr_b16 v[40:41], v22 offset:8192
    ds_read_b64_tr_b16 v[42:43], v22 offset:8704
    ds_read_b64_tr_b16 v[44:45], v22 offset:12288
    ds_read_b64_tr_b16 v[46:47], v22 offset:12800
    ds_read_b64_tr_b16 v[48:49], v22 offset:16384
    ds_read_b64_tr_b16 v[50:51], v22 offset:16896
    ds_read_b64_tr_b16 v[52:53], v22 offset:20480
    ds_read_b64_tr_b16 v[54:55], v22 offset:20992
    s_cmp_eq_u32 s57, 0
    s_cselect_b32 s89, s89, 0
    s_cmp_eq_u32 s89, 0
    s_waitcnt lgkmcnt(0)
    s_barrier
    ds_read_b128 v[160:163], v21 offset:0
    ds_read_b128 v[164:167], v21 offset:64
    ds_read_b128 v[168:171], v21 offset:128
    ds_read_b128 v[172:175], v21 offset:192
    ds_read_b128 v[176:179], v21 offset:256
    ds_read_b128 v[180:183], v21 offset:320
    s_waitcnt lgkmcnt(5)
    v_mfma_f32_16x16x32_bf16 v[140:143], v[32:35], v[160:163], 0
    s_waitcnt lgkmcnt(4)
    v_mfma_f32_16x16x32_bf16 v[140:143], v[36:39], v[164:167], v[140:143]
    s_waitcnt lgkmcnt(3)
    v_mfma_f32_16x16x32_bf16 v[140:143], v[40:43], v[168:171], v[140:143]
    s_waitcnt lgkmcnt(2)
    v_mfma_f32_16x16x32_bf16 v[140:143], v[44:47], v[172:175], v[140:143]
    s_waitcnt lgkmcnt(1)
    v_mfma_f32_16x16x32_bf16 v[140:143], v[48:51], v[176:179], v[140:143]
    s_waitcnt lgkmcnt(0)
    v_mfma_f32_16x16x32_bf16 v[140:143], v[52:55], v[180:183], v[140:143]
    s_nop 7
    v_and_or_b32 v143, v143, s87, v31
    s_cbranch_scc0 L_3st_f
    buffer_store_dwordx4 v[140:143], v11, s[32:35], s21 offen sc1
L_3st_d:
L_exit:
L_end:
    s_endpgm
L_3st_f:
    buffer_store_dwordx4 v[140:143], v11, s[32:35], s21 offen
    s_branch L_3st_d
L_ast_s:
    buffer_store_dwordx2 v[154:155], v3, s[32:35], s16 offen sc1
    s_branch L_ast_d
L_xst_s:
    buffer_store_dwordx4 v[144:147], v19, s[32:35], s19 offen sc1
    s_branch L_xst_d
L_ost_s:
    buffer_store_dwordx4 v[32:35], v16, s[32:35], s15 offen sc1
    s_branch L_ost_d
L_qst_s:
    buffer_store_dwordx4 v[96:99], v13, s[32:35], s90 offen sc1
    s_branch L_qst_d
L_3st_fw:
    buffer_store_dwordx4 v[140:143], v11, s[32:35], s21 offen
    s_branch L_3st_dw
L_hst0_s:
    buffer_store_dword v219, v220, s[32:35], s18 offen sc1
    s_branch L_hst0_d
L_sst_s:
    buffer_store_dwordx4 v[40:43], v6, s[32:35], s91 offen sc1
    s_branch L_sst_d
L_codeend:

.section .rodata,"a"
.p2align 6
.amdhsa_kernel sequential_preLN__sliding_block_cached__geglu_ffn__decode_kernel
  .amdhsa_next_free_vgpr 248
  .amdhsa_next_free_sgpr 102
  .amdhsa_accum_offset 248
  .amdhsa_group_segment_fixed_size 0
  .amdhsa_kernarg_size 96
  .amdhsa_user_sgpr_count 2
  .amdhsa_user_sgpr_kernarg_segment_ptr 1
  .amdhsa_system_sgpr_workgroup_id_x 1
.end_amdhsa_kernel
```
